```python
import torch

def _softmax(x, axis=-1):
    return torch.softmax(x, dim=axis)
def _gelu(x):
    return torch.nn.functional.gelu(x, approximate="tanh")
def _silu(x):
    return torch.nn.functional.silu(x)
def _sigmoid(x):
    return torch.sigmoid(x)
def _layernorm(x, axis=-1, eps=1e-5):
    m = x.mean(dim=axis, keepdim=True)
    v = x.var(dim=axis, keepdim=True, unbiased=False)
    return (x - m) / torch.sqrt(v + eps)
def _scatter_add(tgt, idx, src, axis=0):
    return tgt.clone().index_add_(axis, idx, src)
def _segment_sum(src, seg, n):
    out = torch.zeros((n,) + src.shape[1:], dtype=src.dtype)
    return out.index_add_(0, seg, src)
def _pad(x, pw):
    flat = tuple(v for pair in reversed(pw) for v in pair)
    return torch.nn.functional.pad(x, flat)

kernel_name = 'concat_heads__mha_block__ssm_conv_s4d__prompt'

def setup_inputs():

    _w = (lambda a: (lambda t: t.to(torch.bfloat16) if t.is_floating_point() else t)(torch.as_tensor(a)))
    def _A_setup():
        B, S, D, H = 1, 2048, 512, 32
        return {
            "x": _w((lambda *s: torch.randn(*s, dtype=torch.bfloat16) * 0.2)(B, S, D)),
            "wqkv": _w((lambda *s: torch.randn(*s, dtype=torch.bfloat16) * 0.2)(D, 3 * D)),
            "wo": _w((lambda *s: torch.randn(*s, dtype=torch.bfloat16) * 0.05)(D, D)),
        }
    _A_in = _A_setup()

    def _B_setup():
        Bsz, L, D, N = 1, 2048, 512, 128
        return {
            "u": _w((lambda *s: torch.randn(*s, dtype=torch.bfloat16) * 0.05)(Bsz, L, D)),
            "log_A_real": _w((lambda *s: torch.randn(*s, dtype=torch.bfloat16) * 6.4)(D, N) * 0.5),
            "A_imag": _w((lambda *s: torch.randn(*s, dtype=torch.bfloat16) * 0.05)(D, N) * 3.14),
            "C_real": _w((lambda *s: torch.randn(*s, dtype=torch.bfloat16) * 0.4)(D, N) / N ** 0.5),
            "C_imag": _w((lambda *s: torch.randn(*s, dtype=torch.bfloat16) * 0.4)(D, N) / N ** 0.5),
            "log_dt": _w((lambda *s: torch.randn(*s, dtype=torch.bfloat16) * 0.05)(D) * 0.5 - 4.0),
            "D_skip": _w((lambda *s: torch.randn(*s, dtype=torch.bfloat16) * 0.05)(D)),
        }
    _B_in = _B_setup()

    return {
        "A_x": _A_in["x"],
        "A_wqkv": _A_in["wqkv"],
        "A_wo": _A_in["wo"],
        "B_u": _B_in["u"],
        "B_log_A_real": _B_in["log_A_real"],
        "B_A_imag": _B_in["A_imag"],
        "B_C_real": _B_in["C_real"],
        "B_C_imag": _B_in["C_imag"],
        "B_log_dt": _B_in["log_dt"],
        "B_D_skip": _B_in["D_skip"],
    }

def reference(A_x, A_wqkv, A_wo, B_u, B_log_A_real, B_A_imag, B_C_real, B_C_imag, B_log_dt, B_D_skip):
    def _A_ref(x, wqkv, wo):
        B, S, D = x.shape
        H = 32
        Dh = D // H
        qkv = (lambda x, *d: x.permute(*d))((x @ wqkv).reshape(B, S, 3, H, Dh), 2, 0, 3, 1, 4)
        q, k, v = qkv[0], qkv[1], qkv[2]
        scores = torch.einsum("bhqd,bhkd->bhqk", q, k) * (Dh ** -0.5)
        p = _softmax(scores, axis=-1)
        o = torch.einsum("bhqk,bhkd->bhqd", p, v)
        return (lambda x, *d: x.permute(*d))(o, 0, 2, 1, 3).reshape(B, S, D) @ wo

    def _B_ref(u, log_A_real, A_imag, C_real, C_imag, log_dt, D_skip):
        L = u.shape[1]
        dt = torch.exp(log_dt)
        A = -torch.exp(log_A_real) + 1j * A_imag
        C = (C_real + 1j * C_imag) * dt[:, None]
        pos = (lambda x, dt: x.to(dt))(torch.arange(L), log_dt.dtype)
        P = torch.exp((A * dt[:, None])[:, :, None] * pos[None, None, :])
        K = 2.0 * torch.einsum("dn,dnl->dl", C, P).real
        L2 = 2 * L
        u_t = (lambda x, *d: x.permute(*d))(u, 0, 2, 1)
        Kf = (lambda x, *a, **k: torch.fft.rfft(x.float(), *a, **k))(K, L2)
        Uf = (lambda x, *a, **k: torch.fft.rfft(x.float(), *a, **k))(u_t, L2)
        y = (lambda x, *a, **k: torch.fft.irfft(x, *a, **k).to(torch.bfloat16))(Uf * Kf[None, :, :], L2)[:, :, :L]
        y = (lambda x, *d: x.permute(*d))(y, 0, 2, 1)
        return y + u * D_skip[None, None, :]

    a = _A_ref(A_x, A_wqkv, A_wo)
    b = _B_ref(B_u, B_log_A_real, B_A_imag, B_C_real, B_C_imag, B_log_dt, B_D_skip)
    return torch.concatenate([a, b], axis=-1)
```

```asm
; @launch grid=(256,1,1) block=(768,1,1) lds=163840
.amdgcn_target "amdgcn-amd-amdhsa--gfx950"
.text
.globl concat_heads__mha_block__ssm_conv_s4d__prompt_kernel
    .p2align 8
    .type concat_heads__mha_block__ssm_conv_s4d__prompt_kernel,@function
concat_heads__mha_block__ssm_conv_s4d__prompt_kernel:
    s_cmp_ge_u32 s2, 256
    s_cbranch_scc1 mega_exit
    s_load_dwordx4 s[4:7], s[0:1], 0
    s_load_dwordx2 s[8:9], s[0:1], 96
    v_lshrrev_b32 v2, 6, v0
    v_and_b32 v1, 63, v0
    s_and_b32 s24, s2, 7
    v_readfirstlane_b32 s33, v2
    s_lshr_b32 s25, s2, 3
    s_and_b32 s26, s24, 3
    s_lshl_b32 s26, s26, 3
    s_and_b32 s27, s25, 7
    s_add_u32 s26, s26, s27
    s_lshr_b32 s27, s24, 2
    s_lshl_b32 s27, s27, 2
    s_lshr_b32 s28, s25, 3
    s_add_u32 s27, s27, s28
    s_cmp_ge_u32 s33, 8
    s_cbranch_scc1 k1_kgen
    s_cmp_lt_u32 s33, 4
    s_cbranch_scc1 k1_comp
k1_load:
    s_sub_u32 s33, s33, 4
    s_lshl_b32 s28, s27, 1
    s_add_u32 s28, s28, s26
    s_and_b32 s28, s28, 7
    s_lshl_b32 s29, s33, 10
    s_add_u32 s29, s29, 65536
    s_lshl_b32 s30, s33, 11
    s_lshl_b32 s31, s26, 6
    s_lshl_b32 s32, s33, 4
    s_add_u32 s31, s31, s32
    v_lshrrev_b32 v9, 3, v1
    v_add_u32 v2, s31, v9
    v_lshlrev_b32 v2, 10, v2
    v_lshrrev_b32 v10, 1, v9
    v_xor_b32 v10, v10, v1
    v_and_b32 v10, 7, v10
    v_lshlrev_b32 v10, 4, v10
    v_add_u32 v3, v2, v10
    v_xor_b32 v10, 64, v10
    v_add_u32 v2, v2, v10
    v_add_u32 v2, 8192, v2
    s_lshl_b32 s32, s33, 3
    v_add_u32 v10, s32, v9
    v_mul_u32_u24 v4, 3072, v10
    v_bfe_u32 v11, v9, 1, 1
    v_lshlrev_b32 v11, 2, v11
    v_xor_b32 v11, v11, v1
    v_and_b32 v11, 7, v11
    v_lshlrev_b32 v11, 4, v11
    s_lshl_b32 s32, s27, 7
    v_add3_u32 v4, v4, v11, s32
    v_add_u32 v5, 1024, v4
    v_add_u32 v12, 2048, v4
    s_waitcnt lgkmcnt(0)
    s_mov_b32 s12, s4
    s_and_b32 s13, s5, 0xffff
    s_mov_b32 s14, 0x200000
    s_mov_b32 s15, 0x20000
    s_mov_b32 s16, s6
    s_and_b32 s17, s7, 0xffff
    s_mov_b32 s18, 0x180000
    s_mov_b32 s19, 0x20000
    s_add_u32 s36, s28, 0
    s_and_b32 s36, s36, 7
    s_lshl_b32 s37, s36, 7
    s_mul_i32 s38, s36, 196608
    s_add_u32 m0, s30, 0
    s_add_u32 s39, s38, 98304
    buffer_load_dwordx4 v3, s[12:15], s37 offen lds
    s_add_u32 m0, s30, 1024
    s_nop 0
    buffer_load_dwordx4 v2, s[12:15], s37 offen lds
    s_add_u32 m0, s29, 0
    s_nop 0
    buffer_load_dwordx4 v5, s[16:19], s38 offen lds
    s_add_u32 m0, s29, 4096
    s_nop 0
    buffer_load_dwordx4 v12, s[16:19], s38 offen lds
    s_add_u32 m0, s29, 8192
    s_nop 0
    buffer_load_dwordx4 v5, s[16:19], s39 offen lds
    s_add_u32 m0, s29, 12288
    s_nop 0
    buffer_load_dwordx4 v12, s[16:19], s39 offen lds
    s_add_u32 s36, s28, 1
    s_and_b32 s36, s36, 7
    s_lshl_b32 s37, s36, 7
    s_mul_i32 s38, s36, 196608
    s_add_u32 m0, s30, 8192
    s_add_u32 s39, s38, 98304
    buffer_load_dwordx4 v3, s[12:15], s37 offen lds
    s_add_u32 m0, s30, 9216
    s_nop 0
    buffer_load_dwordx4 v2, s[12:15], s37 offen lds
    s_add_u32 m0, s29, 16384
    s_nop 0
    buffer_load_dwordx4 v5, s[16:19], s38 offen lds
    s_add_u32 m0, s29, 20480
    s_nop 0
    buffer_load_dwordx4 v12, s[16:19], s38 offen lds
    s_add_u32 m0, s29, 24576
    s_nop 0
    buffer_load_dwordx4 v5, s[16:19], s39 offen lds
    s_add_u32 m0, s29, 28672
    s_nop 0
    buffer_load_dwordx4 v12, s[16:19], s39 offen lds
    s_waitcnt vmcnt(6)
    s_barrier
    s_add_u32 s36, s28, 2
    s_and_b32 s36, s36, 7
    s_lshl_b32 s37, s36, 7
    s_mul_i32 s38, s36, 196608
    s_add_u32 m0, s30, 16384
    s_add_u32 s39, s38, 98304
    buffer_load_dwordx4 v3, s[12:15], s37 offen lds
    s_add_u32 m0, s30, 17408
    s_nop 0
    buffer_load_dwordx4 v2, s[12:15], s37 offen lds
    s_add_u32 m0, s29, 32768
    s_nop 0
    buffer_load_dwordx4 v5, s[16:19], s38 offen lds
    s_add_u32 m0, s29, 36864
    s_nop 0
    buffer_load_dwordx4 v12, s[16:19], s38 offen lds
    s_add_u32 m0, s29, 40960
    s_nop 0
    buffer_load_dwordx4 v5, s[16:19], s39 offen lds
    s_add_u32 m0, s29, 45056
    s_nop 0
    buffer_load_dwordx4 v12, s[16:19], s39 offen lds
    s_add_u32 s36, s28, 3
    s_and_b32 s36, s36, 7
    s_lshl_b32 s37, s36, 7
    s_mul_i32 s38, s36, 196608
    s_add_u32 m0, s30, 24576
    s_add_u32 s39, s38, 98304
    buffer_load_dwordx4 v3, s[12:15], s37 offen lds
    s_add_u32 m0, s30, 25600
    s_nop 0
    buffer_load_dwordx4 v2, s[12:15], s37 offen lds
    s_add_u32 m0, s29, 49152
    s_nop 0
    buffer_load_dwordx4 v5, s[16:19], s38 offen lds
    s_add_u32 m0, s29, 53248
    s_nop 0
    buffer_load_dwordx4 v12, s[16:19], s38 offen lds
    s_add_u32 m0, s29, 57344
    s_nop 0
    buffer_load_dwordx4 v5, s[16:19], s39 offen lds
    s_add_u32 m0, s29, 61440
    s_nop 0
    buffer_load_dwordx4 v12, s[16:19], s39 offen lds
    s_waitcnt vmcnt(12)
    s_barrier
    s_add_u32 s36, s28, 4
    s_and_b32 s36, s36, 7
    s_lshl_b32 s37, s36, 7
    s_mul_i32 s38, s36, 196608
    s_add_u32 m0, s30, 32768
    s_add_u32 s39, s38, 98304
    buffer_load_dwordx4 v3, s[12:15], s37 offen lds
    s_add_u32 m0, s30, 33792
    s_nop 0
    buffer_load_dwordx4 v2, s[12:15], s37 offen lds
    s_add_u32 m0, s29, 0
    s_nop 0
    buffer_load_dwordx4 v5, s[16:19], s38 offen lds
    s_add_u32 m0, s29, 4096
    s_nop 0
    buffer_load_dwordx4 v12, s[16:19], s38 offen lds
    s_add_u32 m0, s29, 8192
    s_nop 0
    buffer_load_dwordx4 v5, s[16:19], s39 offen lds
    s_add_u32 m0, s29, 12288
    s_nop 0
    buffer_load_dwordx4 v12, s[16:19], s39 offen lds
    s_waitcnt vmcnt(12)
    s_barrier
    s_add_u32 s36, s28, 5
    s_and_b32 s36, s36, 7
    s_lshl_b32 s37, s36, 7
    s_mul_i32 s38, s36, 196608
    s_add_u32 m0, s30, 40960
    s_add_u32 s39, s38, 98304
    buffer_load_dwordx4 v3, s[12:15], s37 offen lds
    s_add_u32 m0, s30, 41984
    s_nop 0
    buffer_load_dwordx4 v2, s[12:15], s37 offen lds
    s_add_u32 m0, s29, 16384
    s_nop 0
    buffer_load_dwordx4 v5, s[16:19], s38 offen lds
    s_add_u32 m0, s29, 20480
    s_nop 0
    buffer_load_dwordx4 v12, s[16:19], s38 offen lds
    s_add_u32 m0, s29, 24576
    s_nop 0
    buffer_load_dwordx4 v5, s[16:19], s39 offen lds
    s_add_u32 m0, s29, 28672
    s_nop 0
    buffer_load_dwordx4 v12, s[16:19], s39 offen lds
    s_waitcnt vmcnt(12)
    s_barrier
    s_add_u32 s36, s28, 6
    s_and_b32 s36, s36, 7
    s_lshl_b32 s37, s36, 7
    s_mul_i32 s38, s36, 196608
    s_add_u32 m0, s30, 49152
    s_add_u32 s39, s38, 98304
    buffer_load_dwordx4 v3, s[12:15], s37 offen lds
    s_add_u32 m0, s30, 50176
    s_nop 0
    buffer_load_dwordx4 v2, s[12:15], s37 offen lds
    s_add_u32 m0, s29, 32768
    s_nop 0
    buffer_load_dwordx4 v5, s[16:19], s38 offen lds
    s_add_u32 m0, s29, 36864
    s_nop 0
    buffer_load_dwordx4 v12, s[16:19], s38 offen lds
    s_add_u32 m0, s29, 40960
    s_nop 0
    buffer_load_dwordx4 v5, s[16:19], s39 offen lds
    s_add_u32 m0, s29, 45056
    s_nop 0
    buffer_load_dwordx4 v12, s[16:19], s39 offen lds
    s_waitcnt vmcnt(12)
    s_barrier
    s_add_u32 s36, s28, 7
    s_and_b32 s36, s36, 7
    s_lshl_b32 s37, s36, 7
    s_mul_i32 s38, s36, 196608
    s_add_u32 m0, s30, 57344
    s_add_u32 s39, s38, 98304
    buffer_load_dwordx4 v3, s[12:15], s37 offen lds
    s_add_u32 m0, s30, 58368
    s_nop 0
    buffer_load_dwordx4 v2, s[12:15], s37 offen lds
    s_add_u32 m0, s29, 49152
    s_nop 0
    buffer_load_dwordx4 v5, s[16:19], s38 offen lds
    s_add_u32 m0, s29, 53248
    s_nop 0
    buffer_load_dwordx4 v12, s[16:19], s38 offen lds
    s_add_u32 m0, s29, 57344
    s_nop 0
    buffer_load_dwordx4 v5, s[16:19], s39 offen lds
    s_add_u32 m0, s29, 61440
    s_nop 0
    buffer_load_dwordx4 v12, s[16:19], s39 offen lds
    s_waitcnt vmcnt(12)
    s_barrier
    s_add_u32 s36, s28, 0
    s_and_b32 s36, s36, 7
    s_mul_i32 s38, s36, 196608
    s_add_u32 s39, s38, 98304
    s_add_u32 m0, s29, 0
    s_nop 0
    buffer_load_dwordx4 v4, s[16:19], s38 offen lds
    s_add_u32 m0, s29, 4096
    s_nop 0
    buffer_load_dwordx4 v4, s[16:19], s39 offen lds
    s_add_u32 s36, s28, 1
    s_and_b32 s36, s36, 7
    s_mul_i32 s38, s36, 196608
    s_add_u32 s39, s38, 98304
    s_add_u32 m0, s29, 8192
    s_nop 0
    buffer_load_dwordx4 v4, s[16:19], s38 offen lds
    s_add_u32 m0, s29, 12288
    s_nop 0
    buffer_load_dwordx4 v4, s[16:19], s39 offen lds
    s_waitcnt vmcnt(10)
    s_barrier
    s_add_u32 s36, s28, 2
    s_and_b32 s36, s36, 7
    s_mul_i32 s38, s36, 196608
    s_add_u32 s39, s38, 98304
    s_add_u32 m0, s29, 16384
    s_nop 0
    buffer_load_dwordx4 v4, s[16:19], s38 offen lds
    s_add_u32 m0, s29, 20480
    s_nop 0
    buffer_load_dwordx4 v4, s[16:19], s39 offen lds
    s_add_u32 s36, s28, 3
    s_and_b32 s36, s36, 7
    s_mul_i32 s38, s36, 196608
    s_add_u32 s39, s38, 98304
    s_add_u32 m0, s29, 24576
    s_nop 0
    buffer_load_dwordx4 v4, s[16:19], s38 offen lds
    s_add_u32 m0, s29, 28672
    s_nop 0
    buffer_load_dwordx4 v4, s[16:19], s39 offen lds
    s_waitcnt vmcnt(8)
    s_barrier
    s_add_u32 s36, s28, 4
    s_and_b32 s36, s36, 7
    s_mul_i32 s38, s36, 196608
    s_add_u32 s39, s38, 98304
    s_add_u32 m0, s29, 32768
    s_nop 0
    buffer_load_dwordx4 v4, s[16:19], s38 offen lds
    s_add_u32 m0, s29, 36864
    s_nop 0
    buffer_load_dwordx4 v4, s[16:19], s39 offen lds
    s_add_u32 s36, s28, 5
    s_and_b32 s36, s36, 7
    s_mul_i32 s38, s36, 196608
    s_add_u32 s39, s38, 98304
    s_add_u32 m0, s29, 40960
    s_nop 0
    buffer_load_dwordx4 v4, s[16:19], s38 offen lds
    s_add_u32 m0, s29, 45056
    s_nop 0
    buffer_load_dwordx4 v4, s[16:19], s39 offen lds
    s_waitcnt vmcnt(10)
    s_barrier
    s_add_u32 s36, s28, 6
    s_and_b32 s36, s36, 7
    s_mul_i32 s38, s36, 196608
    s_add_u32 s39, s38, 98304
    s_add_u32 m0, s29, 49152
    s_nop 0
    buffer_load_dwordx4 v4, s[16:19], s38 offen lds
    s_add_u32 m0, s29, 53248
    s_nop 0
    buffer_load_dwordx4 v4, s[16:19], s39 offen lds
    s_add_u32 s36, s28, 7
    s_and_b32 s36, s36, 7
    s_mul_i32 s38, s36, 196608
    s_add_u32 s39, s38, 98304
    s_add_u32 m0, s29, 57344
    s_nop 0
    buffer_load_dwordx4 v4, s[16:19], s38 offen lds
    s_add_u32 m0, s29, 61440
    s_nop 0
    buffer_load_dwordx4 v4, s[16:19], s39 offen lds
    s_waitcnt vmcnt(12)
    s_barrier
    s_waitcnt vmcnt(10)
    s_barrier
    s_waitcnt vmcnt(8)
    s_barrier
    s_waitcnt vmcnt(6)
    s_barrier
    s_waitcnt vmcnt(4)
    s_barrier
    s_waitcnt vmcnt(2)
    s_barrier
    s_waitcnt vmcnt(0)
    s_barrier
    s_barrier
    s_branch p2_entry
k1_comp:
    s_or_b32 s36, s2, s33
    s_cmp_lg_u32 s36, 0
    s_cbranch_scc1 cp_nozc_1
    s_load_dwordx2 s[10:11], s[0:1], 88
    v_lshlrev_b32 v8, 12, v1
    v_add_u32 v8, 12582912, v8
    v_mov_b32 v9, 0
    s_waitcnt lgkmcnt(0)
    s_mov_b32 s20, s8
    s_and_b32 s21, s9, 0xffff
    s_mov_b32 s22, 0x10000000
    s_mov_b32 s23, 0x20000
    s_mov_b32 s44, s10
    s_and_b32 s45, s11, 0xffff
    s_mov_b32 s46, 0x100
    s_mov_b32 s47, 0x20000
    buffer_store_dword v9, v8, s[20:23], 0 offen sc1
    v_add_u32 v10, 262144, v8
    buffer_store_dword v9, v10, s[20:23], 0 offen sc1
    v_add_u32 v10, 524288, v8
    buffer_store_dword v9, v10, s[20:23], 0 offen sc1
    v_mov_b32 v8, 0
    s_mov_b64 exec, 1
    buffer_load_dword v10, v8, s[44:47], 0 offen sc1
    s_waitcnt vmcnt(0)
    v_mov_b32 v9, 1
    buffer_store_dword v9, v8, s[44:47], 0 offen sc1
    s_mov_b64 exec, -1
cp_nozc_1:
    s_and_b32 s34, s33, 1
    s_lshr_b32 s35, s33, 1
    v_and_b32 v9, 31, v1
    v_lshrrev_b32 v10, 5, v1
    v_bfe_u32 v11, v1, 1, 3
    v_xor_b32 v11, v11, v10
    v_lshlrev_b32 v11, 4, v11
    v_lshlrev_b32 v9, 7, v9
    s_lshl_b32 s36, s34, 12
    v_add3_u32 v6, v9, v11, s36
    v_xor_b32 v7, 32, v6
    v_xor_b32 v13, 64, v6
    v_xor_b32 v14, 96, v6
    v_lshrrev_b32 v9, 5, v1
    v_lshlrev_b32 v9, 3, v9
    v_bfe_u32 v10, v1, 2, 2
    v_add_u32 v9, v9, v10
    v_lshlrev_b32 v9, 7, v9
    v_bfe_u32 v10, v1, 3, 1
    v_xor_b32 v10, s35, v10
    v_lshlrev_b32 v10, 6, v10
    v_add_u32 v9, v9, v10
    v_bfe_u32 v10, v1, 4, 1
    v_lshlrev_b32 v10, 5, v10
    v_and_b32 v11, 1, v1
    v_lshlrev_b32 v11, 4, v11
    v_add3_u32 v9, v9, v10, v11
    v_bfe_u32 v10, v1, 1, 1
    v_lshlrev_b32 v10, 3, v10
    v_add_u32 v8, v9, v10
    v_add_u32 v8, 65536, v8
    v_mov_b32 v16, 0
    v_mov_b32 v17, 0
    v_mov_b32 v18, 0
    v_mov_b32 v19, 0
    v_mov_b32 v20, 0
    v_mov_b32 v21, 0
    v_mov_b32 v22, 0
    v_mov_b32 v23, 0
    v_mov_b32 v24, 0
    v_mov_b32 v25, 0
    v_mov_b32 v26, 0
    v_mov_b32 v27, 0
    v_mov_b32 v28, 0
    v_mov_b32 v29, 0
    v_mov_b32 v30, 0
    v_mov_b32 v31, 0
    v_mov_b32 v32, 0
    v_mov_b32 v33, 0
    v_mov_b32 v34, 0
    v_mov_b32 v35, 0
    v_mov_b32 v36, 0
    v_mov_b32 v37, 0
    v_mov_b32 v38, 0
    v_mov_b32 v39, 0
    v_mov_b32 v40, 0
    v_mov_b32 v41, 0
    v_mov_b32 v42, 0
    v_mov_b32 v43, 0
    v_mov_b32 v44, 0
    v_mov_b32 v45, 0
    v_mov_b32 v46, 0
    v_mov_b32 v47, 0
    v_mov_b32 v48, 0
    v_mov_b32 v49, 0
    v_mov_b32 v50, 0
    v_mov_b32 v51, 0
    v_mov_b32 v52, 0
    v_mov_b32 v53, 0
    v_mov_b32 v54, 0
    v_mov_b32 v55, 0
    v_mov_b32 v56, 0
    v_mov_b32 v57, 0
    v_mov_b32 v58, 0
    v_mov_b32 v59, 0
    v_mov_b32 v60, 0
    v_mov_b32 v61, 0
    v_mov_b32 v62, 0
    v_mov_b32 v63, 0
    s_load_dwordx2 s[10:11], s[0:1], 88
    s_waitcnt lgkmcnt(0)
    s_mov_b32 s20, s8
    s_and_b32 s21, s9, 0xffff
    s_mov_b32 s22, 0x10000000
    s_mov_b32 s23, 0x20000
    s_mov_b32 s44, s10
    s_and_b32 s45, s11, 0xffff
    s_mov_b32 s46, 0x100
    s_mov_b32 s47, 0x20000
    s_lshl_b32 s36, s27, 2
    s_lshl_b32 s37, s35, 1
    s_add_u32 s36, s36, s37
    s_lshl_b32 s36, s36, 6
    s_lshl_b32 s37, s26, 1
    s_add_u32 s36, s36, s37
    s_add_u32 s36, s36, s34
    s_lshl_b32 s36, s36, 10
    s_add_u32 s37, s36, 65536
    v_lshlrev_b32 v9, 4, v1
    v_bfe_u32 v10, v1, 4, 1
    v_lshlrev_b32 v10, 16, v10
    v_lshrrev_b32 v11, 5, v1
    v_lshlrev_b32 v11, 8, v11
    v_and_b32 v12, 15, v1
    v_lshlrev_b32 v12, 4, v12
    v_add3_u32 v10, v10, v11, v12
    s_add_u32 s38, s36, 2097152
    s_add_u32 s39, s37, 2097152
    s_add_u32 s40, s36, 4194304
    s_waitcnt lgkmcnt(0)
    s_barrier
    ds_read_b128 v[64:67], v6 offset:0
    ds_read_b64_tr_b16 v[68:69], v8 offset:0
    ds_read_b64_tr_b16 v[70:71], v8 offset:512
    ds_read_b64_tr_b16 v[72:73], v8 offset:4096
    ds_read_b64_tr_b16 v[74:75], v8 offset:4608
    ds_read_b128 v[76:79], v7 offset:0
    ds_read_b64_tr_b16 v[80:81], v8 offset:2048
    ds_read_b64_tr_b16 v[82:83], v8 offset:2560
    ds_read_b64_tr_b16 v[84:85], v8 offset:6144
    ds_read_b64_tr_b16 v[86:87], v8 offset:6656
    ds_read_b128 v[88:91], v13 offset:0
    ds_read_b64_tr_b16 v[92:93], v8 offset:8192
    ds_read_b64_tr_b16 v[94:95], v8 offset:8704
    ds_read_b64_tr_b16 v[96:97], v8 offset:12288
    ds_read_b64_tr_b16 v[98:99], v8 offset:12800
    ds_read_b128 v[100:103], v14 offset:0
    ds_read_b64_tr_b16 v[104:105], v8 offset:10240
    ds_read_b64_tr_b16 v[106:107], v8 offset:10752
    ds_read_b64_tr_b16 v[108:109], v8 offset:14336
    ds_read_b64_tr_b16 v[110:111], v8 offset:14848
    s_waitcnt lgkmcnt(0)
    s_barrier
    v_mfma_f32_32x32x16_bf16 v[16:31], v[68:71], v[64:67], v[16:31]
    ds_read_b128 v[112:115], v6 offset:8192
    ds_read_b64_tr_b16 v[116:117], v8 offset:16384
    ds_read_b64_tr_b16 v[118:119], v8 offset:16896
    ds_read_b64_tr_b16 v[120:121], v8 offset:20480
    ds_read_b64_tr_b16 v[122:123], v8 offset:20992
    v_mfma_f32_32x32x16_bf16 v[32:47], v[64:67], v[72:75], v[32:47]
    ds_read_b128 v[124:127], v7 offset:8192
    ds_read_b64_tr_b16 v[128:129], v8 offset:18432
    ds_read_b64_tr_b16 v[130:131], v8 offset:18944
    ds_read_b64_tr_b16 v[132:133], v8 offset:22528
    ds_read_b64_tr_b16 v[134:135], v8 offset:23040
    v_mfma_f32_32x32x16_bf16 v[16:31], v[80:83], v[76:79], v[16:31]
    ds_read_b128 v[136:139], v13 offset:8192
    ds_read_b64_tr_b16 v[140:141], v8 offset:24576
    ds_read_b64_tr_b16 v[142:143], v8 offset:25088
    ds_read_b64_tr_b16 v[144:145], v8 offset:28672
    ds_read_b64_tr_b16 v[146:147], v8 offset:29184
    v_mfma_f32_32x32x16_bf16 v[32:47], v[76:79], v[84:87], v[32:47]
    ds_read_b128 v[148:151], v14 offset:8192
    ds_read_b64_tr_b16 v[152:153], v8 offset:26624
    ds_read_b64_tr_b16 v[154:155], v8 offset:27136
    ds_read_b64_tr_b16 v[156:157], v8 offset:30720
    ds_read_b64_tr_b16 v[158:159], v8 offset:31232
    v_mfma_f32_32x32x16_bf16 v[16:31], v[92:95], v[88:91], v[16:31]
    v_mfma_f32_32x32x16_bf16 v[32:47], v[88:91], v[96:99], v[32:47]
    v_mfma_f32_32x32x16_bf16 v[16:31], v[104:107], v[100:103], v[16:31]
    v_mfma_f32_32x32x16_bf16 v[32:47], v[100:103], v[108:111], v[32:47]
    s_waitcnt lgkmcnt(0)
    s_barrier
    v_mfma_f32_32x32x16_bf16 v[16:31], v[116:119], v[112:115], v[16:31]
    ds_read_b128 v[64:67], v6 offset:16384
    ds_read_b64_tr_b16 v[68:69], v8 offset:32768
    ds_read_b64_tr_b16 v[70:71], v8 offset:33280
    ds_read_b64_tr_b16 v[72:73], v8 offset:36864
    ds_read_b64_tr_b16 v[74:75], v8 offset:37376
    v_mfma_f32_32x32x16_bf16 v[32:47], v[112:115], v[120:123], v[32:47]
    ds_read_b128 v[76:79], v7 offset:16384
    ds_read_b64_tr_b16 v[80:81], v8 offset:34816
    ds_read_b64_tr_b16 v[82:83], v8 offset:35328
    ds_read_b64_tr_b16 v[84:85], v8 offset:38912
    ds_read_b64_tr_b16 v[86:87], v8 offset:39424
    v_mfma_f32_32x32x16_bf16 v[16:31], v[128:131], v[124:127], v[16:31]
    ds_read_b128 v[88:91], v13 offset:16384
    ds_read_b64_tr_b16 v[92:93], v8 offset:40960
    ds_read_b64_tr_b16 v[94:95], v8 offset:41472
    ds_read_b64_tr_b16 v[96:97], v8 offset:45056
    ds_read_b64_tr_b16 v[98:99], v8 offset:45568
    v_mfma_f32_32x32x16_bf16 v[32:47], v[124:127], v[132:135], v[32:47]
    ds_read_b128 v[100:103], v14 offset:16384
    ds_read_b64_tr_b16 v[104:105], v8 offset:43008
    ds_read_b64_tr_b16 v[106:107], v8 offset:43520
    ds_read_b64_tr_b16 v[108:109], v8 offset:47104
    ds_read_b64_tr_b16 v[110:111], v8 offset:47616
    v_mfma_f32_32x32x16_bf16 v[16:31], v[140:143], v[136:139], v[16:31]
    v_mfma_f32_32x32x16_bf16 v[32:47], v[136:139], v[144:147], v[32:47]
    v_mfma_f32_32x32x16_bf16 v[16:31], v[152:155], v[148:151], v[16:31]
    v_mfma_f32_32x32x16_bf16 v[32:47], v[148:151], v[156:159], v[32:47]
    s_waitcnt lgkmcnt(0)
    s_barrier
    v_mfma_f32_32x32x16_bf16 v[16:31], v[68:71], v[64:67], v[16:31]
    ds_read_b128 v[112:115], v6 offset:24576
    ds_read_b64_tr_b16 v[116:117], v8 offset:49152
    ds_read_b64_tr_b16 v[118:119], v8 offset:49664
    ds_read_b64_tr_b16 v[120:121], v8 offset:53248
    ds_read_b64_tr_b16 v[122:123], v8 offset:53760
    v_mfma_f32_32x32x16_bf16 v[32:47], v[64:67], v[72:75], v[32:47]
    ds_read_b128 v[124:127], v7 offset:24576
    ds_read_b64_tr_b16 v[128:129], v8 offset:51200
    ds_read_b64_tr_b16 v[130:131], v8 offset:51712
    ds_read_b64_tr_b16 v[132:133], v8 offset:55296
    ds_read_b64_tr_b16 v[134:135], v8 offset:55808
    v_mfma_f32_32x32x16_bf16 v[16:31], v[80:83], v[76:79], v[16:31]
    ds_read_b128 v[136:139], v13 offset:24576
    ds_read_b64_tr_b16 v[140:141], v8 offset:57344
    ds_read_b64_tr_b16 v[142:143], v8 offset:57856
    ds_read_b64_tr_b16 v[144:145], v8 offset:61440
    ds_read_b64_tr_b16 v[146:147], v8 offset:61952
    v_mfma_f32_32x32x16_bf16 v[32:47], v[76:79], v[84:87], v[32:47]
    ds_read_b128 v[148:151], v14 offset:24576
    ds_read_b64_tr_b16 v[152:153], v8 offset:59392
    ds_read_b64_tr_b16 v[154:155], v8 offset:59904
    ds_read_b64_tr_b16 v[156:157], v8 offset:63488
    ds_read_b64_tr_b16 v[158:159], v8 offset:64000
    v_mfma_f32_32x32x16_bf16 v[16:31], v[92:95], v[88:91], v[16:31]
    v_mfma_f32_32x32x16_bf16 v[32:47], v[88:91], v[96:99], v[32:47]
    v_mfma_f32_32x32x16_bf16 v[16:31], v[104:107], v[100:103], v[16:31]
    v_mfma_f32_32x32x16_bf16 v[32:47], v[100:103], v[108:111], v[32:47]
    s_waitcnt lgkmcnt(0)
    s_barrier
    v_mfma_f32_32x32x16_bf16 v[16:31], v[116:119], v[112:115], v[16:31]
    ds_read_b128 v[64:67], v6 offset:32768
    ds_read_b64_tr_b16 v[68:69], v8 offset:0
    ds_read_b64_tr_b16 v[70:71], v8 offset:512
    ds_read_b64_tr_b16 v[72:73], v8 offset:4096
    ds_read_b64_tr_b16 v[74:75], v8 offset:4608
    v_mfma_f32_32x32x16_bf16 v[32:47], v[112:115], v[120:123], v[32:47]
    ds_read_b128 v[76:79], v7 offset:32768
    ds_read_b64_tr_b16 v[80:81], v8 offset:2048
    ds_read_b64_tr_b16 v[82:83], v8 offset:2560
    ds_read_b64_tr_b16 v[84:85], v8 offset:6144
    ds_read_b64_tr_b16 v[86:87], v8 offset:6656
    v_mfma_f32_32x32x16_bf16 v[16:31], v[128:131], v[124:127], v[16:31]
    ds_read_b128 v[88:91], v13 offset:32768
    ds_read_b64_tr_b16 v[92:93], v8 offset:8192
    ds_read_b64_tr_b16 v[94:95], v8 offset:8704
    ds_read_b64_tr_b16 v[96:97], v8 offset:12288
    ds_read_b64_tr_b16 v[98:99], v8 offset:12800
    v_mfma_f32_32x32x16_bf16 v[32:47], v[124:127], v[132:135], v[32:47]
    ds_read_b128 v[100:103], v14 offset:32768
    ds_read_b64_tr_b16 v[104:105], v8 offset:10240
    ds_read_b64_tr_b16 v[106:107], v8 offset:10752
    ds_read_b64_tr_b16 v[108:109], v8 offset:14336
    ds_read_b64_tr_b16 v[110:111], v8 offset:14848
    v_mfma_f32_32x32x16_bf16 v[16:31], v[140:143], v[136:139], v[16:31]
    v_mfma_f32_32x32x16_bf16 v[32:47], v[136:139], v[144:147], v[32:47]
    v_mfma_f32_32x32x16_bf16 v[16:31], v[152:155], v[148:151], v[16:31]
    v_mfma_f32_32x32x16_bf16 v[32:47], v[148:151], v[156:159], v[32:47]
    s_waitcnt lgkmcnt(0)
    s_barrier
    v_mfma_f32_32x32x16_bf16 v[16:31], v[68:71], v[64:67], v[16:31]
    ds_read_b128 v[112:115], v6 offset:40960
    ds_read_b64_tr_b16 v[116:117], v8 offset:16384
    ds_read_b64_tr_b16 v[118:119], v8 offset:16896
    ds_read_b64_tr_b16 v[120:121], v8 offset:20480
    ds_read_b64_tr_b16 v[122:123], v8 offset:20992
    v_mfma_f32_32x32x16_bf16 v[32:47], v[64:67], v[72:75], v[32:47]
    ds_read_b128 v[124:127], v7 offset:40960
    ds_read_b64_tr_b16 v[128:129], v8 offset:18432
    ds_read_b64_tr_b16 v[130:131], v8 offset:18944
    ds_read_b64_tr_b16 v[132:133], v8 offset:22528
    ds_read_b64_tr_b16 v[134:135], v8 offset:23040
    v_mfma_f32_32x32x16_bf16 v[16:31], v[80:83], v[76:79], v[16:31]
    ds_read_b128 v[136:139], v13 offset:40960
    ds_read_b64_tr_b16 v[140:141], v8 offset:24576
    ds_read_b64_tr_b16 v[142:143], v8 offset:25088
    ds_read_b64_tr_b16 v[144:145], v8 offset:28672
    ds_read_b64_tr_b16 v[146:147], v8 offset:29184
    v_mfma_f32_32x32x16_bf16 v[32:47], v[76:79], v[84:87], v[32:47]
    ds_read_b128 v[148:151], v14 offset:40960
    ds_read_b64_tr_b16 v[152:153], v8 offset:26624
    ds_read_b64_tr_b16 v[154:155], v8 offset:27136
    ds_read_b64_tr_b16 v[156:157], v8 offset:30720
    ds_read_b64_tr_b16 v[158:159], v8 offset:31232
    v_mfma_f32_32x32x16_bf16 v[16:31], v[92:95], v[88:91], v[16:31]
    v_mfma_f32_32x32x16_bf16 v[32:47], v[88:91], v[96:99], v[32:47]
    v_mfma_f32_32x32x16_bf16 v[16:31], v[104:107], v[100:103], v[16:31]
    v_mfma_f32_32x32x16_bf16 v[32:47], v[100:103], v[108:111], v[32:47]
    s_waitcnt lgkmcnt(0)
    s_barrier
    v_mfma_f32_32x32x16_bf16 v[16:31], v[116:119], v[112:115], v[16:31]
    ds_read_b128 v[64:67], v6 offset:49152
    ds_read_b64_tr_b16 v[68:69], v8 offset:32768
    ds_read_b64_tr_b16 v[70:71], v8 offset:33280
    ds_read_b64_tr_b16 v[72:73], v8 offset:36864
    ds_read_b64_tr_b16 v[74:75], v8 offset:37376
    v_mfma_f32_32x32x16_bf16 v[32:47], v[112:115], v[120:123], v[32:47]
    ds_read_b128 v[76:79], v7 offset:49152
    ds_read_b64_tr_b16 v[80:81], v8 offset:34816
    ds_read_b64_tr_b16 v[82:83], v8 offset:35328
    ds_read_b64_tr_b16 v[84:85], v8 offset:38912
    ds_read_b64_tr_b16 v[86:87], v8 offset:39424
    v_mfma_f32_32x32x16_bf16 v[16:31], v[128:131], v[124:127], v[16:31]
    ds_read_b128 v[88:91], v13 offset:49152
    ds_read_b64_tr_b16 v[92:93], v8 offset:40960
    ds_read_b64_tr_b16 v[94:95], v8 offset:41472
    ds_read_b64_tr_b16 v[96:97], v8 offset:45056
    ds_read_b64_tr_b16 v[98:99], v8 offset:45568
    v_mfma_f32_32x32x16_bf16 v[32:47], v[124:127], v[132:135], v[32:47]
    ds_read_b128 v[100:103], v14 offset:49152
    ds_read_b64_tr_b16 v[104:105], v8 offset:43008
    ds_read_b64_tr_b16 v[106:107], v8 offset:43520
    ds_read_b64_tr_b16 v[108:109], v8 offset:47104
    ds_read_b64_tr_b16 v[110:111], v8 offset:47616
    v_mfma_f32_32x32x16_bf16 v[16:31], v[140:143], v[136:139], v[16:31]
    v_mfma_f32_32x32x16_bf16 v[32:47], v[136:139], v[144:147], v[32:47]
    v_mfma_f32_32x32x16_bf16 v[16:31], v[152:155], v[148:151], v[16:31]
    v_mfma_f32_32x32x16_bf16 v[32:47], v[148:151], v[156:159], v[32:47]
    s_waitcnt lgkmcnt(0)
    s_barrier
    v_mfma_f32_32x32x16_bf16 v[16:31], v[68:71], v[64:67], v[16:31]
    ds_read_b128 v[112:115], v6 offset:57344
    ds_read_b64_tr_b16 v[116:117], v8 offset:49152
    ds_read_b64_tr_b16 v[118:119], v8 offset:49664
    ds_read_b64_tr_b16 v[120:121], v8 offset:53248
    ds_read_b64_tr_b16 v[122:123], v8 offset:53760
    v_mfma_f32_32x32x16_bf16 v[32:47], v[64:67], v[72:75], v[32:47]
    ds_read_b128 v[124:127], v7 offset:57344
    ds_read_b64_tr_b16 v[128:129], v8 offset:51200
    ds_read_b64_tr_b16 v[130:131], v8 offset:51712
    ds_read_b64_tr_b16 v[132:133], v8 offset:55296
    ds_read_b64_tr_b16 v[134:135], v8 offset:55808
    v_mfma_f32_32x32x16_bf16 v[16:31], v[80:83], v[76:79], v[16:31]
    ds_read_b128 v[136:139], v13 offset:57344
    ds_read_b64_tr_b16 v[140:141], v8 offset:57344
    ds_read_b64_tr_b16 v[142:143], v8 offset:57856
    ds_read_b64_tr_b16 v[144:145], v8 offset:61440
    ds_read_b64_tr_b16 v[146:147], v8 offset:61952
    v_mfma_f32_32x32x16_bf16 v[32:47], v[76:79], v[84:87], v[32:47]
    ds_read_b128 v[148:151], v14 offset:57344
    ds_read_b64_tr_b16 v[152:153], v8 offset:59392
    ds_read_b64_tr_b16 v[154:155], v8 offset:59904
    ds_read_b64_tr_b16 v[156:157], v8 offset:63488
    ds_read_b64_tr_b16 v[158:159], v8 offset:64000
    v_mfma_f32_32x32x16_bf16 v[16:31], v[92:95], v[88:91], v[16:31]
    v_mfma_f32_32x32x16_bf16 v[32:47], v[88:91], v[96:99], v[32:47]
    v_mfma_f32_32x32x16_bf16 v[16:31], v[104:107], v[100:103], v[16:31]
    v_mfma_f32_32x32x16_bf16 v[32:47], v[100:103], v[108:111], v[32:47]
    s_waitcnt lgkmcnt(0)
    s_barrier
    v_mfma_f32_32x32x16_bf16 v[16:31], v[116:119], v[112:115], v[16:31]
    ds_read_b128 v[64:67], v6 offset:0
    ds_read_b64_tr_b16 v[68:69], v8 offset:0
    ds_read_b64_tr_b16 v[70:71], v8 offset:512
    ds_read_b128 v[76:79], v7 offset:0
    v_mfma_f32_32x32x16_bf16 v[32:47], v[112:115], v[120:123], v[32:47]
    ds_read_b64_tr_b16 v[80:81], v8 offset:2048
    ds_read_b64_tr_b16 v[82:83], v8 offset:2560
    ds_read_b128 v[88:91], v13 offset:0
    ds_read_b64_tr_b16 v[92:93], v8 offset:4096
    v_mfma_f32_32x32x16_bf16 v[16:31], v[128:131], v[124:127], v[16:31]
    ds_read_b64_tr_b16 v[94:95], v8 offset:4608
    ds_read_b128 v[100:103], v14 offset:0
    ds_read_b64_tr_b16 v[104:105], v8 offset:6144
    ds_read_b64_tr_b16 v[106:107], v8 offset:6656
    v_mfma_f32_32x32x16_bf16 v[32:47], v[124:127], v[132:135], v[32:47]
    v_mfma_f32_32x32x16_bf16 v[16:31], v[140:143], v[136:139], v[16:31]
    v_mfma_f32_32x32x16_bf16 v[32:47], v[136:139], v[144:147], v[32:47]
    v_mfma_f32_32x32x16_bf16 v[16:31], v[152:155], v[148:151], v[16:31]
    v_mfma_f32_32x32x16_bf16 v[32:47], v[148:151], v[156:159], v[32:47]
    s_waitcnt lgkmcnt(0)
    s_barrier
    v_mfma_f32_32x32x16_bf16 v[48:63], v[68:71], v[64:67], v[48:63]
    ds_read_b128 v[112:115], v6 offset:8192
    ds_read_b64_tr_b16 v[116:117], v8 offset:8192
    ds_read_b64_tr_b16 v[118:119], v8 offset:8704
    ds_read_b128 v[124:127], v7 offset:8192
    v_mfma_f32_32x32x16_bf16 v[48:63], v[80:83], v[76:79], v[48:63]
    ds_read_b64_tr_b16 v[128:129], v8 offset:10240
    ds_read_b64_tr_b16 v[130:131], v8 offset:10752
    ds_read_b128 v[136:139], v13 offset:8192
    ds_read_b64_tr_b16 v[140:141], v8 offset:12288
    v_mfma_f32_32x32x16_bf16 v[48:63], v[92:95], v[88:91], v[48:63]
    ds_read_b64_tr_b16 v[142:143], v8 offset:12800
    ds_read_b128 v[148:151], v14 offset:8192
    ds_read_b64_tr_b16 v[152:153], v8 offset:14336
    ds_read_b64_tr_b16 v[154:155], v8 offset:14848
    v_mfma_f32_32x32x16_bf16 v[48:63], v[104:107], v[100:103], v[48:63]
    v_cvt_pk_bf16_f32 v16, v16, v17
    v_cvt_pk_bf16_f32 v17, v18, v19
    v_cvt_pk_bf16_f32 v18, v20, v21
    v_cvt_pk_bf16_f32 v19, v22, v23
    v_cvt_pk_bf16_f32 v20, v24, v25
    v_cvt_pk_bf16_f32 v21, v26, v27
    v_cvt_pk_bf16_f32 v22, v28, v29
    v_cvt_pk_bf16_f32 v23, v30, v31
    buffer_store_dwordx4 v[16:19], v9, s[20:23], s38 offen sc1
    buffer_store_dwordx4 v[20:23], v9, s[20:23], s39 offen sc1
    s_waitcnt lgkmcnt(0)
    s_barrier
    v_mfma_f32_32x32x16_bf16 v[48:63], v[116:119], v[112:115], v[48:63]
    ds_read_b128 v[64:67], v6 offset:16384
    ds_read_b64_tr_b16 v[68:69], v8 offset:16384
    ds_read_b64_tr_b16 v[70:71], v8 offset:16896
    ds_read_b128 v[76:79], v7 offset:16384
    v_mfma_f32_32x32x16_bf16 v[48:63], v[128:131], v[124:127], v[48:63]
    ds_read_b64_tr_b16 v[80:81], v8 offset:18432
    ds_read_b64_tr_b16 v[82:83], v8 offset:18944
    ds_read_b128 v[88:91], v13 offset:16384
    ds_read_b64_tr_b16 v[92:93], v8 offset:20480
    v_mfma_f32_32x32x16_bf16 v[48:63], v[140:143], v[136:139], v[48:63]
    ds_read_b64_tr_b16 v[94:95], v8 offset:20992
    ds_read_b128 v[100:103], v14 offset:16384
    ds_read_b64_tr_b16 v[104:105], v8 offset:22528
    ds_read_b64_tr_b16 v[106:107], v8 offset:23040
    v_mfma_f32_32x32x16_bf16 v[48:63], v[152:155], v[148:151], v[48:63]
    v_cvt_pk_bf16_f32 v32, v32, v33
    v_cvt_pk_bf16_f32 v33, v34, v35
    v_cvt_pk_bf16_f32 v34, v36, v37
    v_cvt_pk_bf16_f32 v35, v38, v39
    v_cvt_pk_bf16_f32 v36, v40, v41
    v_cvt_pk_bf16_f32 v37, v42, v43
    v_cvt_pk_bf16_f32 v38, v44, v45
    v_cvt_pk_bf16_f32 v39, v46, v47
    buffer_store_dwordx4 v[32:35], v10, s[20:23], s40 offen sc1
    buffer_store_dwordx4 v[36:39], v10, s[20:23], s40 offen offset:512 sc1
    v_mov_b32 v2, 0
    buffer_load_dword v3, v2, s[44:47], 0 offen sc1
    v_mov_b32 v4, 163328
    v_mov_b32 v5, 1
    s_waitcnt lgkmcnt(0)
    s_barrier
    v_mfma_f32_32x32x16_bf16 v[48:63], v[68:71], v[64:67], v[48:63]
    ds_read_b128 v[112:115], v6 offset:24576
    ds_read_b64_tr_b16 v[116:117], v8 offset:24576
    ds_read_b64_tr_b16 v[118:119], v8 offset:25088
    ds_read_b128 v[124:127], v7 offset:24576
    v_mfma_f32_32x32x16_bf16 v[48:63], v[80:83], v[76:79], v[48:63]
    ds_read_b64_tr_b16 v[128:129], v8 offset:26624
    ds_read_b64_tr_b16 v[130:131], v8 offset:27136
    ds_read_b128 v[136:139], v13 offset:24576
    ds_read_b64_tr_b16 v[140:141], v8 offset:28672
    v_mfma_f32_32x32x16_bf16 v[48:63], v[92:95], v[88:91], v[48:63]
    ds_read_b64_tr_b16 v[142:143], v8 offset:29184
    ds_read_b128 v[148:151], v14 offset:24576
    ds_read_b64_tr_b16 v[152:153], v8 offset:30720
    ds_read_b64_tr_b16 v[154:155], v8 offset:31232
    v_mfma_f32_32x32x16_bf16 v[48:63], v[104:107], v[100:103], v[48:63]
    s_waitcnt lgkmcnt(0)
    s_barrier
    v_mfma_f32_32x32x16_bf16 v[48:63], v[116:119], v[112:115], v[48:63]
    ds_read_b128 v[64:67], v6 offset:32768
    ds_read_b64_tr_b16 v[68:69], v8 offset:32768
    ds_read_b64_tr_b16 v[70:71], v8 offset:33280
    ds_read_b128 v[76:79], v7 offset:32768
    v_mfma_f32_32x32x16_bf16 v[48:63], v[128:131], v[124:127], v[48:63]
    ds_read_b64_tr_b16 v[80:81], v8 offset:34816
    ds_read_b64_tr_b16 v[82:83], v8 offset:35328
    ds_read_b128 v[88:91], v13 offset:32768
    ds_read_b64_tr_b16 v[92:93], v8 offset:36864
    v_mfma_f32_32x32x16_bf16 v[48:63], v[140:143], v[136:139], v[48:63]
    ds_read_b64_tr_b16 v[94:95], v8 offset:37376
    ds_read_b128 v[100:103], v14 offset:32768
    ds_read_b64_tr_b16 v[104:105], v8 offset:38912
    ds_read_b64_tr_b16 v[106:107], v8 offset:39424
    v_mfma_f32_32x32x16_bf16 v[48:63], v[152:155], v[148:151], v[48:63]
    s_waitcnt lgkmcnt(0)
    s_barrier
    v_mfma_f32_32x32x16_bf16 v[48:63], v[68:71], v[64:67], v[48:63]
    ds_read_b128 v[112:115], v6 offset:40960
    ds_read_b64_tr_b16 v[116:117], v8 offset:40960
    ds_read_b64_tr_b16 v[118:119], v8 offset:41472
    ds_read_b128 v[124:127], v7 offset:40960
    v_mfma_f32_32x32x16_bf16 v[48:63], v[80:83], v[76:79], v[48:63]
    ds_read_b64_tr_b16 v[128:129], v8 offset:43008
    ds_read_b64_tr_b16 v[130:131], v8 offset:43520
    ds_read_b128 v[136:139], v13 offset:40960
    ds_read_b64_tr_b16 v[140:141], v8 offset:45056
    v_mfma_f32_32x32x16_bf16 v[48:63], v[92:95], v[88:91], v[48:63]
    ds_read_b64_tr_b16 v[142:143], v8 offset:45568
    ds_read_b128 v[148:151], v14 offset:40960
    ds_read_b64_tr_b16 v[152:153], v8 offset:47104
    ds_read_b64_tr_b16 v[154:155], v8 offset:47616
    v_mfma_f32_32x32x16_bf16 v[48:63], v[104:107], v[100:103], v[48:63]
    s_waitcnt vmcnt(0)
    s_mov_b64 exec, 1
    ds_add_u32 v4, v5 offset:28
    s_mov_b64 exec, -1
    s_waitcnt lgkmcnt(0)
    s_barrier
    v_mfma_f32_32x32x16_bf16 v[48:63], v[116:119], v[112:115], v[48:63]
    ds_read_b128 v[64:67], v6 offset:49152
    ds_read_b64_tr_b16 v[68:69], v8 offset:49152
    ds_read_b64_tr_b16 v[70:71], v8 offset:49664
    ds_read_b128 v[76:79], v7 offset:49152
    v_mfma_f32_32x32x16_bf16 v[48:63], v[128:131], v[124:127], v[48:63]
    ds_read_b64_tr_b16 v[80:81], v8 offset:51200
    ds_read_b64_tr_b16 v[82:83], v8 offset:51712
    ds_read_b128 v[88:91], v13 offset:49152
    ds_read_b64_tr_b16 v[92:93], v8 offset:53248
    v_mfma_f32_32x32x16_bf16 v[48:63], v[140:143], v[136:139], v[48:63]
    ds_read_b64_tr_b16 v[94:95], v8 offset:53760
    ds_read_b128 v[100:103], v14 offset:49152
    ds_read_b64_tr_b16 v[104:105], v8 offset:55296
    ds_read_b64_tr_b16 v[106:107], v8 offset:55808
    v_mfma_f32_32x32x16_bf16 v[48:63], v[152:155], v[148:151], v[48:63]
    s_cmp_lg_u32 s33, 0
    s_cbranch_scc1 cp_nokv_2
    v_readfirstlane_b32 s41, v3
    s_nop 2
    s_cmp_lg_u32 s41, 0
    s_cbranch_scc1 cp_rdy2_3
    s_mov_b32 s42, 0
    v_mov_b32 v2, 0
    s_mov_b32 s43, 0
spg_4:
    buffer_load_dword v3, v2, s[44:47], s42 offen sc1
    s_waitcnt vmcnt(0)
    v_readfirstlane_b32 s41, v3
    s_add_u32 s43, s43, 1
    s_nop 2
    s_cmp_ge_u32 s41, 1
    s_cbranch_scc1 spgd_5
    s_cmp_ge_u32 s43, 0x80000
    s_cbranch_scc1 spgd_5
    s_sleep 1
    s_branch spg_4
spgd_5:
cp_rdy2_3:
    s_mov_b32 s43, 0
spl_6:
    ds_read_b32 v2, v4 offset:28
    s_waitcnt lgkmcnt(0)
    v_readfirstlane_b32 s41, v2
    s_add_u32 s43, s43, 1
    s_nop 2
    s_cmp_ge_u32 s41, 4
    s_cbranch_scc1 spld_7
    s_cmp_ge_u32 s43, 0x400000
    s_cbranch_scc1 spld_7
    s_sleep 1
    s_branch spl_6
spld_7:
    s_lshl_b32 s41, s27, 12
    s_add_u32 s41, s41, 12582912
    v_mov_b32 v2, 0
    s_mov_b64 exec, 1
    buffer_atomic_add v5, v2, s[20:23], s41 offen
    s_mov_b64 exec, -1
cp_nokv_2:
    s_waitcnt lgkmcnt(0)
    s_barrier
    v_mfma_f32_32x32x16_bf16 v[48:63], v[68:71], v[64:67], v[48:63]
    ds_read_b128 v[112:115], v6 offset:57344
    ds_read_b64_tr_b16 v[116:117], v8 offset:57344
    ds_read_b64_tr_b16 v[118:119], v8 offset:57856
    ds_read_b128 v[124:127], v7 offset:57344
    v_mfma_f32_32x32x16_bf16 v[48:63], v[80:83], v[76:79], v[48:63]
    ds_read_b64_tr_b16 v[128:129], v8 offset:59392
    ds_read_b64_tr_b16 v[130:131], v8 offset:59904
    ds_read_b128 v[136:139], v13 offset:57344
    ds_read_b64_tr_b16 v[140:141], v8 offset:61440
    v_mfma_f32_32x32x16_bf16 v[48:63], v[92:95], v[88:91], v[48:63]
    ds_read_b64_tr_b16 v[142:143], v8 offset:61952
    ds_read_b128 v[148:151], v14 offset:57344
    ds_read_b64_tr_b16 v[152:153], v8 offset:63488
    ds_read_b64_tr_b16 v[154:155], v8 offset:64000
    v_mfma_f32_32x32x16_bf16 v[48:63], v[104:107], v[100:103], v[48:63]
    s_waitcnt lgkmcnt(0)
    v_mfma_f32_32x32x16_bf16 v[48:63], v[116:119], v[112:115], v[48:63]
    v_mfma_f32_32x32x16_bf16 v[48:63], v[128:131], v[124:127], v[48:63]
    v_mfma_f32_32x32x16_bf16 v[48:63], v[140:143], v[136:139], v[48:63]
    v_mfma_f32_32x32x16_bf16 v[48:63], v[152:155], v[148:151], v[48:63]
    s_nop 11
    s_mov_b32 s41, 0x3eb8aa3b
    v_mul_f32 v48, s41, v48
    v_mul_f32 v49, s41, v49
    v_mul_f32 v50, s41, v50
    v_mul_f32 v51, s41, v51
    v_mul_f32 v52, s41, v52
    v_mul_f32 v53, s41, v53
    v_mul_f32 v54, s41, v54
    v_mul_f32 v55, s41, v55
    v_mul_f32 v56, s41, v56
    v_mul_f32 v57, s41, v57
    v_mul_f32 v58, s41, v58
    v_mul_f32 v59, s41, v59
    v_mul_f32 v60, s41, v60
    v_mul_f32 v61, s41, v61
    v_mul_f32 v62, s41, v62
    v_mul_f32 v63, s41, v63
    v_cvt_pk_bf16_f32 v48, v48, v49
    v_cvt_pk_bf16_f32 v49, v50, v51
    v_cvt_pk_bf16_f32 v50, v52, v53
    v_cvt_pk_bf16_f32 v51, v54, v55
    v_cvt_pk_bf16_f32 v52, v56, v57
    v_cvt_pk_bf16_f32 v53, v58, v59
    v_cvt_pk_bf16_f32 v54, v60, v61
    v_cvt_pk_bf16_f32 v55, v62, v63
    buffer_store_dwordx4 v[48:51], v9, s[20:23], s36 offen sc1
    buffer_store_dwordx4 v[52:55], v9, s[20:23], s37 offen sc1
    s_barrier
    s_waitcnt vmcnt(0)
    v_mov_b32 v112, 163328
    v_mov_b32 v113, 1
    s_mov_b64 exec, 1
    ds_add_u32 v112, v113 offset:24
    s_mov_b64 exec, -1
    s_branch p2_entry
k1_kgen:
    s_load_dwordx8 s[12:19], s[0:1], 32
    s_load_dwordx4 s[56:59], s[0:1], 64
    s_load_dwordx2 s[44:45], s[0:1], 24
    s_load_dwordx2 s[46:47], s[0:1], 88
    s_sub_u32 s33, s33, 8
    s_lshl_b32 s24, s24, 5
    s_add_u32 s24, s24, s25
    s_lshr_b32 s28, s33, 1
    s_and_b32 s32, s33, 1
    s_lshl_b32 s29, s24, 1
    s_add_u32 s29, s29, s28
    s_lshl_b32 s30, s29, 8
    s_lshl_b32 s31, s32, 7
    s_add_u32 s30, s30, s31
    s_lshl_b32 s25, s24, 2
    v_lshlrev_b32 v2, 1, v1
    s_waitcnt lgkmcnt(0)
    s_load_dword s26, s[56:57], s25
    s_load_dword s27, s[58:59], s25
    s_mov_b32 s36, s12
    s_and_b32 s37, s13, 0xffff
    s_mov_b32 s38, 0x20000
    s_mov_b32 s39, 0x20000
    s_mov_b32 s40, s14
    s_and_b32 s41, s15, 0xffff
    s_mov_b32 s42, 0x20000
    s_mov_b32 s43, 0x20000
    s_mov_b32 s48, s16
    s_and_b32 s49, s17, 0xffff
    s_mov_b32 s50, 0x20000
    s_mov_b32 s51, 0x20000
    s_mov_b32 s52, s18
    s_and_b32 s53, s19, 0xffff
    s_mov_b32 s54, 0x20000
    s_mov_b32 s55, 0x20000
    buffer_load_ushort v4, v2, s[36:39], s30 offen
    buffer_load_ushort v5, v2, s[40:43], s30 offen
    buffer_load_ushort v6, v2, s[48:51], s30 offen
    buffer_load_ushort v7, v2, s[52:55], s30 offen
    s_mov_b32 s20, s8
    s_and_b32 s21, s9, 0xffff
    s_mov_b32 s22, 0x10000000
    s_mov_b32 s23, 0x20000
    s_mov_b32 s60, s44
    s_and_b32 s61, s45, 0xffff
    s_mov_b32 s62, 0x200000
    s_mov_b32 s63, 0x20000
    s_mov_b32 s12, s32
    s_mov_b32 s14, s46
    s_mov_b32 s15, s47
    s_mov_b32 s16, s14
    s_and_b32 s17, s15, 0xffff
    s_mov_b32 s18, 0x100
    s_mov_b32 s19, 0x20000
    s_cmp_lg_u32 s33, 1
    s_cbranch_scc1 kg_nout_8
    v_lshrrev_b32 v8, 3, v1
    v_lshlrev_b32 v8, 10, v8
    v_and_b32 v9, 7, v1
    v_lshlrev_b32 v9, 4, v9
    v_add_u32 v8, v8, v9
    s_lshr_b32 s31, s2, 3
    s_lshl_b32 s31, s31, 16
    s_and_b32 s32, s2, 7
    s_lshl_b32 s32, s32, 7
    s_add_u32 s31, s31, s32
    s_mov_b32 m0, 153856
    s_nop 0
    buffer_load_dwordx4 v8, s[60:63], s31 offen lds
    s_add_u32 s31, s31, 8192
    s_mov_b32 m0, 154880
    s_nop 0
    buffer_load_dwordx4 v8, s[60:63], s31 offen lds
    s_add_u32 s31, s31, 8192
    s_mov_b32 m0, 155904
    s_nop 0
    buffer_load_dwordx4 v8, s[60:63], s31 offen lds
    s_add_u32 s31, s31, 8192
    s_mov_b32 m0, 156928
    s_nop 0
    buffer_load_dwordx4 v8, s[60:63], s31 offen lds
    s_add_u32 s31, s31, 8192
    s_mov_b32 m0, 157952
    s_nop 0
    buffer_load_dwordx4 v8, s[60:63], s31 offen lds
    s_add_u32 s31, s31, 8192
    s_mov_b32 m0, 158976
    s_nop 0
    buffer_load_dwordx4 v8, s[60:63], s31 offen lds
    s_add_u32 s31, s31, 8192
    s_mov_b32 m0, 160000
    s_nop 0
    buffer_load_dwordx4 v8, s[60:63], s31 offen lds
    s_add_u32 s31, s31, 8192
    s_mov_b32 m0, 161024
    s_nop 0
    buffer_load_dwordx4 v8, s[60:63], s31 offen lds
    s_add_u32 s31, s31, 8192
kg_nout_8:
    s_mul_i32 s31, s33, 4160
    s_add_u32 s31, s31, 141312
    v_lshlrev_b32 v8, 2, v1
    v_add_u32 v8, s31, v8
    v_mov_b32 v9, 0
    s_mov_b32 exec_lo, 0xffff
    s_mov_b32 exec_hi, 0
    ds_write_b32 v8, v9
    s_cmp_lg_u32 s33, 2
    s_cbranch_scc1 kg_nofl_9
    v_lshlrev_b32 v8, 2, v1
    v_add_u32 v8, 163328, v8
    ds_write_b32 v8, v9
kg_nofl_9:
    s_mov_b64 exec, -1
    s_mul_i32 s34, s33, 5696
    s_add_u32 s34, s34, 16384
    s_mul_i32 s13, s28, 11392
    s_add_u32 s13, s13, 16384
    v_and_b32 v12, 15, v1
    v_cvt_f32_u32 v13, v12
    s_lshl_b32 s35, s28, 11
    s_lshl_b32 s31, s12, 10
    s_add_u32 s35, s35, s31
    s_add_u32 s35, s35, 131072
    v_lshlrev_b32 v10, 4, v1
    v_add_u32 v10, s35, v10
    v_lshrrev_b32 v11, 4, v1
    v_lshlrev_b32 v11, 6, v11
    v_add_u32 v11, s35, v11
    v_lshrrev_b32 v16, 4, v1
    v_lshlrev_b32 v16, 6, v16
    v_add_u32 v16, v16, v12
    v_cvt_f32_u32 v16, v16
    v_mov_b32 v136, v16
    v_lshrrev_b32 v136, 14, v136
    v_subrev_u32 v136, 0xfdfc, v136
    v_max_i32 v136, 0, v136
    v_add_u32 v136, s34, v136
    v_add_f32 v137, 0x41800000, v16
    v_lshrrev_b32 v137, 14, v137
    v_subrev_u32 v137, 0xfdfc, v137
    v_max_i32 v137, 0, v137
    v_add_u32 v137, s34, v137
    v_add_f32 v138, 0x42000000, v16
    v_lshrrev_b32 v138, 14, v138
    v_subrev_u32 v138, 0xfdfc, v138
    v_max_i32 v138, 0, v138
    v_add_u32 v138, s34, v138
    v_add_f32 v139, 0x42400000, v16
    v_lshrrev_b32 v139, 14, v139
    v_subrev_u32 v139, 0xfdfc, v139
    v_max_i32 v139, 0, v139
    v_add_u32 v139, s34, v139
    s_lshl_b32 s35, s12, 10
    v_lshlrev_b32 v14, 3, v1
    v_add_u32 v14, s35, v14
    v_sub_u32 v17, 2047, v14
    v_cvt_f32_i32 v17, v17
    s_mov_b32 s35, 0x3f7f3f7f
    v_mov_b32 v16, 0x450b0000
    v_add_f32 v18, 0x0, v17
    v_add_f32 v19, 0xc4000000, v17
    v_cvt_pk_bf16_f32 v140, v18, v19
    v_add_f32 v18, 0xbf800000, v17
    v_add_f32 v19, 0xc4004000, v17
    v_cvt_pk_bf16_f32 v141, v18, v19
    v_add_f32 v18, 0xc0000000, v17
    v_add_f32 v19, 0xc4008000, v17
    v_cvt_pk_bf16_f32 v142, v18, v19
    v_add_f32 v18, 0xc0400000, v17
    v_add_f32 v19, 0xc400c000, v17
    v_cvt_pk_bf16_f32 v143, v18, v19
    v_add_f32 v18, 0xc0800000, v17
    v_add_f32 v19, 0xc4010000, v17
    v_cvt_pk_bf16_f32 v144, v18, v19
    v_add_f32 v18, 0xc0a00000, v17
    v_add_f32 v19, 0xc4014000, v17
    v_cvt_pk_bf16_f32 v145, v18, v19
    v_add_f32 v18, 0xc0c00000, v17
    v_add_f32 v19, 0xc4018000, v17
    v_cvt_pk_bf16_f32 v146, v18, v19
    v_add_f32 v18, 0xc0e00000, v17
    v_add_f32 v19, 0xc401c000, v17
    v_cvt_pk_bf16_f32 v147, v18, v19
    v_add_f32 v18, 0xc1000000, v17
    v_add_f32 v19, 0xc4020000, v17
    v_cmp_gt_f32 vcc, 0, v19
    s_nop 1
    v_cndmask_b32 v19, v19, v16, vcc
    v_cvt_pk_bf16_f32 v148, v18, v19
    v_add_f32 v18, 0xc1100000, v17
    v_add_f32 v19, 0xc4024000, v17
    v_cmp_gt_f32 vcc, 0, v19
    s_nop 1
    v_cndmask_b32 v19, v19, v16, vcc
    v_cvt_pk_bf16_f32 v149, v18, v19
    v_add_f32 v18, 0xc1200000, v17
    v_add_f32 v19, 0xc4028000, v17
    v_cmp_gt_f32 vcc, 0, v19
    s_nop 1
    v_cndmask_b32 v19, v19, v16, vcc
    v_cvt_pk_bf16_f32 v150, v18, v19
    v_pk_sub_u16 v140, v140, s35 clamp
    v_pk_sub_u16 v141, v141, s35 clamp
    v_pk_sub_u16 v142, v142, s35 clamp
    v_pk_sub_u16 v143, v143, s35 clamp
    v_pk_sub_u16 v144, v144, s35 clamp
    v_pk_sub_u16 v145, v145, s35 clamp
    v_pk_sub_u16 v146, v146, s35 clamp
    v_pk_sub_u16 v147, v147, s35 clamp
    v_pk_sub_u16 v148, v148, s35 clamp
    v_pk_sub_u16 v149, v149, s35 clamp
    v_pk_sub_u16 v150, v150, s35 clamp
    v_pk_lshlrev_b16 v140, 2, v140 op_sel_hi:[0,1]
    v_pk_lshlrev_b16 v141, 2, v141 op_sel_hi:[0,1]
    v_pk_lshlrev_b16 v142, 2, v142 op_sel_hi:[0,1]
    v_pk_lshlrev_b16 v143, 2, v143 op_sel_hi:[0,1]
    v_pk_lshlrev_b16 v144, 2, v144 op_sel_hi:[0,1]
    v_pk_lshlrev_b16 v145, 2, v145 op_sel_hi:[0,1]
    v_pk_lshlrev_b16 v146, 2, v146 op_sel_hi:[0,1]
    v_pk_lshlrev_b16 v147, 2, v147 op_sel_hi:[0,1]
    v_pk_lshlrev_b16 v148, 2, v148 op_sel_hi:[0,1]
    v_pk_lshlrev_b16 v149, 2, v149 op_sel_hi:[0,1]
    v_pk_lshlrev_b16 v150, 2, v150 op_sel_hi:[0,1]
    s_waitcnt lgkmcnt(0)
    s_lshl_b32 s35, s28, 4
    s_lshr_b32 s26, s26, s35
    s_lshl_b32 s26, s26, 16
    s_lshr_b32 s27, s27, s35
    s_lshl_b32 s27, s27, 16
    v_mov_b32 v20, s26
    v_mul_f32 v21, 0x3fb8aa3b, v20
    v_mov_b32 v22, 0x3fb8aa3b
    v_fma_f32 v22, v20, v22, -v21
    v_fmac_f32 v22, 0x32a57060, v20
    v_exp_f32 v21, v21
    v_mul_f32 v22, 0x3f317218, v22
    v_fma_f32 v21, v21, v22, v21
    v_cvt_pk_bf16_f32 v21, v21, v21
    v_lshlrev_b32 v20, 16, v21
    s_barrier
    s_waitcnt vmcnt(0)
    v_lshlrev_b32 v4, 16, v4
    v_lshlrev_b32 v5, 16, v5
    v_lshlrev_b32 v6, 16, v6
    v_lshlrev_b32 v7, 16, v7
    v_mul_f32 v21, 0x3fb8aa3b, v4
    v_mov_b32 v22, 0x3fb8aa3b
    v_fma_f32 v22, v4, v22, -v21
    v_fmac_f32 v22, 0x32a57060, v4
    v_exp_f32 v21, v21
    v_mul_f32 v22, 0x3f317218, v22
    v_fma_f32 v21, v21, v22, v21
    v_cvt_pk_bf16_f32 v21, v21, v21
    v_lshlrev_b32 v4, 16, v21
    v_mul_f32 v4, v4, v20
    v_mul_f32 v4, 0xbfb8aa3b, v4
    v_mul_f32 v5, v5, v20
    v_mul_f32 v5, 0x3e22f983, v5
    v_mul_f32 v6, v6, v20
    v_mul_f32 v7, v7, v20
    v_add_f32 v6, v6, v6
    v_add_f32 v7, v7, v7
    ds_write_b128 v10, v[4:7]
    v_mul_f32 v16, 0x45000000, v4
    v_mul_f32 v17, 0x45000000, v5
    v_exp_f32 v16, v16
    v_fract_f32 v17, v17
    v_cos_f32 v18, v17
    v_sin_f32 v19, v17
    s_nop 0
    v_mul_f32 v18, v18, v6
    v_fma_f32 v18, -v19, v7, v18
    v_mul_f32 v22, v18, v16
    s_nop 1
    v_add_f32_dpp v22, v22, v22 row_shr:1 row_mask:0xf bank_mask:0xf bound_ctrl:0
    s_nop 1
    v_add_f32_dpp v22, v22, v22 row_shr:2 row_mask:0xf bank_mask:0xf bound_ctrl:0
    s_nop 1
    v_add_f32_dpp v22, v22, v22 row_shr:4 row_mask:0xf bank_mask:0xf bound_ctrl:0
    s_nop 1
    v_add_f32_dpp v22, v22, v22 row_shr:8 row_mask:0xf bank_mask:0xf bound_ctrl:0
    s_nop 1
    v_add_f32_dpp v22, v22, v22 row_bcast:15 row_mask:0xa bank_mask:0xf
    s_nop 1
    v_add_f32_dpp v22, v22, v22 row_bcast:31 row_mask:0xc bank_mask:0xf
    v_cmp_eq_u32 vcc, 0, v1
    s_cmp_eq_u32 s12, 0
    s_cselect_b32 s27, s27, 0
    v_mov_b32 v21, s27
    v_cndmask_b32 v21, 0, v21, vcc
    s_waitcnt lgkmcnt(0)
    ds_read_b128 v[88:91], v11 offset:0
    ds_read_b128 v[92:95], v11 offset:16
    ds_read_b128 v[96:99], v11 offset:32
    ds_read_b128 v[100:103], v11 offset:48
    v_mov_b32 v24, 0
    v_mov_b32 v25, 0
    v_mov_b32 v26, 0
    v_mov_b32 v27, 0
    v_mov_b32 v28, 0
    v_mov_b32 v29, 0
    v_mov_b32 v30, 0
    v_mov_b32 v31, 0
    v_mov_b32 v32, 0
    v_mov_b32 v33, 0
    v_mov_b32 v34, 0
    v_mov_b32 v35, 0
    v_mov_b32 v36, 0
    v_mov_b32 v37, 0
    v_mov_b32 v38, 0
    v_mov_b32 v39, 0
    s_mov_b32 s38, 0
    v_mov_b32 v10, v11
    s_branch kg_loop_in
kg_loop:
    s_barrier
kg_loop_in:
    s_cmp_eq_u32 s38, 0
    s_cbranch_scc1 kg_sp_10
kg_spb_11:
    s_cmp_eq_u32 s38, 2
    s_cbranch_scc1 kg_sp_12
kg_spb_13:
    s_waitcnt lgkmcnt(0)
    v_mov_b32 v72, v88
    v_mov_b32 v73, v89
    v_mov_b32 v74, v90
    v_mov_b32 v75, v91
    v_mov_b32 v76, v92
    v_mov_b32 v77, v93
    v_mov_b32 v78, v94
    v_mov_b32 v79, v95
    v_mov_b32 v80, v96
    v_mov_b32 v81, v97
    v_mov_b32 v82, v98
    v_mov_b32 v83, v99
    v_mov_b32 v84, v100
    v_mov_b32 v85, v101
    v_mov_b32 v86, v102
    v_mov_b32 v87, v103
    v_add_u32 v10, 256, v10
    ds_read_b128 v[88:91], v10 offset:0
    ds_read_b128 v[92:95], v10 offset:16
    ds_read_b128 v[96:99], v10 offset:32
    ds_read_b128 v[100:103], v10 offset:48
    v_mul_f32 v108, v72, v13
    v_mul_f32 v116, v76, v13
    v_mul_f32 v124, v80, v13
    v_mul_f32 v132, v84, v13
    v_mul_f32 v109, v73, v13
    v_mul_f32 v117, v77, v13
    v_mul_f32 v125, v81, v13
    v_mul_f32 v133, v85, v13
    v_exp_f32 v108, v108
    v_exp_f32 v116, v116
    v_exp_f32 v124, v124
    v_exp_f32 v132, v132
    v_fract_f32 v109, v109
    v_fract_f32 v117, v117
    v_fract_f32 v125, v125
    v_fract_f32 v133, v133
    v_cos_f32 v104, v109
    v_cos_f32 v112, v117
    v_cos_f32 v120, v125
    v_cos_f32 v128, v133
    v_sin_f32 v105, v109
    v_sin_f32 v113, v117
    v_sin_f32 v121, v125
    v_sin_f32 v129, v133
    v_mul_f32 v104, v104, v108
    v_mul_f32 v112, v112, v116
    v_mul_f32 v120, v120, v124
    v_mul_f32 v128, v128, v132
    v_mul_f32 v105, v105, v108
    v_mul_f32 v113, v113, v116
    v_mul_f32 v121, v121, v124
    v_mul_f32 v129, v129, v132
    v_cvt_pk_bf16_f32 v56, v104, v105
    v_cvt_pk_bf16_f32 v57, v112, v113
    v_cvt_pk_bf16_f32 v58, v120, v121
    v_cvt_pk_bf16_f32 v59, v128, v129
    v_mul_f32 v106, v105, v105
    v_mul_f32 v114, v113, v113
    s_barrier
    s_cmp_eq_u32 s38, 3
    s_cbranch_scc1 kg_sp_14
kg_spb_15:
    v_mul_f32 v122, v121, v121
    v_mul_f32 v130, v129, v129
    v_mul_f32_e64 v105, v104, v105 mul:2
    v_mul_f32_e64 v113, v112, v113 mul:2
    v_mul_f32_e64 v121, v120, v121 mul:2
    v_mul_f32_e64 v129, v128, v129 mul:2
    v_fma_f32 v104, v104, v104, -v106
    v_fma_f32 v112, v112, v112, -v114
    v_fma_f32 v120, v120, v120, -v122
    v_fma_f32 v128, v128, v128, -v130
    v_cvt_pk_bf16_f32 v60, v104, v105
    v_cvt_pk_bf16_f32 v61, v112, v113
    v_cvt_pk_bf16_f32 v62, v120, v121
    v_cvt_pk_bf16_f32 v63, v128, v129
    v_mul_f32 v106, v105, v105
    v_mul_f32 v114, v113, v113
    v_mul_f32 v122, v121, v121
    v_mul_f32 v130, v129, v129
    v_mul_f32_e64 v105, v104, v105 mul:2
    v_mul_f32_e64 v113, v112, v113 mul:2
    v_mul_f32_e64 v121, v120, v121 mul:2
    v_mul_f32_e64 v129, v128, v129 mul:2
    v_fma_f32 v104, v104, v104, -v106
    v_fma_f32 v112, v112, v112, -v114
    v_fma_f32 v120, v120, v120, -v122
    v_fma_f32 v128, v128, v128, -v130
    v_cvt_pk_bf16_f32 v64, v104, v105
    v_cvt_pk_bf16_f32 v65, v112, v113
    v_cvt_pk_bf16_f32 v66, v120, v121
    v_cvt_pk_bf16_f32 v67, v128, v129
    v_mul_f32 v106, v105, v105
    v_mul_f32 v114, v113, v113
    v_mul_f32 v122, v121, v121
    v_mul_f32 v130, v129, v129
    v_mul_f32_e64 v105, v104, v105 mul:2
    v_mul_f32_e64 v113, v112, v113 mul:2
    v_mul_f32_e64 v121, v120, v121 mul:2
    v_mul_f32_e64 v129, v128, v129 mul:2
    v_fma_f32 v104, v104, v104, -v106
    v_fma_f32 v112, v112, v112, -v114
    v_fma_f32 v120, v120, v120, -v122
    v_fma_f32 v128, v128, v128, -v130
    v_cvt_pk_bf16_f32 v68, v104, v105
    v_cvt_pk_bf16_f32 v69, v112, v113
    v_cvt_pk_bf16_f32 v70, v120, v121
    v_cvt_pk_bf16_f32 v71, v128, v129
    v_mul_f32 v106, v105, v105
    v_mul_f32 v114, v113, v113
    v_mul_f32 v122, v121, v121
    v_mul_f32 v130, v129, v129
    v_mul_f32_e64 v105, v104, v105 mul:2
    v_mul_f32_e64 v113, v112, v113 mul:2
    v_mul_f32_e64 v121, v120, v121 mul:2
    v_mul_f32_e64 v129, v128, v129 mul:2
    v_fma_f32 v104, v104, v104, -v106
    v_fma_f32 v112, v112, v112, -v114
    s_barrier
    v_fma_f32 v120, v120, v120, -v122
    v_fma_f32 v128, v128, v128, -v130
    v_mul_f32 v110, v105, v75
    v_mul_f32 v118, v113, v79
    v_mul_f32 v126, v121, v83
    v_mul_f32 v134, v129, v87
    v_mul_f32 v111, v105, v74
    v_mul_f32 v119, v113, v78
    v_mul_f32 v127, v121, v82
    v_mul_f32 v135, v129, v86
    v_fma_f32 v109, v104, v75, v111
    v_fma_f32 v117, v112, v79, v119
    v_fma_f32 v125, v120, v83, v127
    v_fma_f32 v133, v128, v87, v135
    v_fma_f32 v108, v104, v74, -v110
    v_fma_f32 v116, v112, v78, -v118
    v_fma_f32 v124, v120, v82, -v126
    v_fma_f32 v132, v128, v86, -v134
    v_cvt_pk_bf16_f32 v40, v108, -v109
    v_cvt_pk_bf16_f32 v41, v116, -v117
    v_cvt_pk_bf16_f32 v42, v124, -v125
    v_cvt_pk_bf16_f32 v43, v132, -v133
    v_mul_f32 v110, v109, v105
    v_mul_f32 v118, v117, v113
    v_mul_f32 v126, v125, v121
    v_mul_f32 v134, v133, v129
    v_mul_f32 v111, v109, v104
    v_mul_f32 v119, v117, v112
    v_mul_f32 v127, v125, v120
    v_mul_f32 v135, v133, v128
    v_fma_f32 v109, v108, v105, v111
    v_fma_f32 v117, v116, v113, v119
    v_fma_f32 v125, v124, v121, v127
    v_fma_f32 v133, v132, v129, v135
    v_fma_f32 v108, v108, v104, -v110
    v_fma_f32 v116, v116, v112, -v118
    v_fma_f32 v124, v124, v120, -v126
    v_fma_f32 v132, v132, v128, -v134
    v_mul_f32 v106, v105, v105
    v_mul_f32 v114, v113, v113
    v_mul_f32 v122, v121, v121
    v_mul_f32 v130, v129, v129
    v_mul_f32_e64 v105, v104, v105 mul:2
    v_mul_f32_e64 v113, v112, v113 mul:2
    v_mul_f32_e64 v121, v120, v121 mul:2
    v_mul_f32_e64 v129, v128, v129 mul:2
    v_fma_f32 v104, v104, v104, -v106
    v_fma_f32 v112, v112, v112, -v114
    v_fma_f32 v120, v120, v120, -v122
    v_fma_f32 v128, v128, v128, -v130
    v_cvt_pk_bf16_f32 v44, v108, -v109
    v_cvt_pk_bf16_f32 v45, v116, -v117
    v_cvt_pk_bf16_f32 v46, v124, -v125
    v_cvt_pk_bf16_f32 v47, v132, -v133
    v_mul_f32 v110, v109, v105
    v_mul_f32 v118, v117, v113
    s_barrier
    v_mul_f32 v126, v125, v121
    v_mul_f32 v134, v133, v129
    v_mul_f32 v111, v109, v104
    v_mul_f32 v119, v117, v112
    v_mul_f32 v127, v125, v120
    v_mul_f32 v135, v133, v128
    v_fma_f32 v109, v108, v105, v111
    v_fma_f32 v117, v116, v113, v119
    v_fma_f32 v125, v124, v121, v127
    v_fma_f32 v133, v132, v129, v135
    v_fma_f32 v108, v108, v104, -v110
    v_fma_f32 v116, v116, v112, -v118
    v_fma_f32 v124, v124, v120, -v126
    v_fma_f32 v132, v132, v128, -v134
    v_mul_f32 v106, v105, v105
    v_mul_f32 v114, v113, v113
    v_mul_f32 v122, v121, v121
    v_mul_f32 v130, v129, v129
    v_mul_f32_e64 v105, v104, v105 mul:2
    v_mul_f32_e64 v113, v112, v113 mul:2
    v_mul_f32_e64 v121, v120, v121 mul:2
    v_mul_f32_e64 v129, v128, v129 mul:2
    v_fma_f32 v104, v104, v104, -v106
    v_fma_f32 v112, v112, v112, -v114
    v_fma_f32 v120, v120, v120, -v122
    v_fma_f32 v128, v128, v128, -v130
    v_cvt_pk_bf16_f32 v48, v108, -v109
    v_cvt_pk_bf16_f32 v49, v116, -v117
    v_cvt_pk_bf16_f32 v50, v124, -v125
    v_cvt_pk_bf16_f32 v51, v132, -v133
    v_mul_f32 v110, v109, v105
    v_mul_f32 v118, v117, v113
    v_mul_f32 v126, v125, v121
    v_mul_f32 v134, v133, v129
    v_mul_f32 v111, v109, v104
    v_mul_f32 v119, v117, v112
    v_mul_f32 v127, v125, v120
    v_mul_f32 v135, v133, v128
    v_fma_f32 v109, v108, v105, v111
    v_fma_f32 v117, v116, v113, v119
    v_fma_f32 v125, v124, v121, v127
    v_fma_f32 v133, v132, v129, v135
    v_fma_f32 v108, v108, v104, -v110
    v_fma_f32 v116, v116, v112, -v118
    v_fma_f32 v124, v124, v120, -v126
    v_fma_f32 v132, v132, v128, -v134
    v_cvt_pk_bf16_f32 v52, v108, -v109
    v_cvt_pk_bf16_f32 v53, v116, -v117
    v_cvt_pk_bf16_f32 v54, v124, -v125
    v_cvt_pk_bf16_f32 v55, v132, -v133
    s_nop 1
    v_mfma_f32_16x16x32_bf16 v[24:27], v[40:43], v[56:59], v[24:27]
    v_mfma_f32_16x16x32_bf16 v[28:31], v[44:47], v[60:63], v[28:31]
    v_mfma_f32_16x16x32_bf16 v[32:35], v[48:51], v[64:67], v[32:35]
    v_mfma_f32_16x16x32_bf16 v[36:39], v[52:55], v[68:71], v[36:39]
    s_add_u32 s38, s38, 1
    s_cmp_lt_u32 s38, 4
    s_cbranch_scc1 kg_loop
    s_branch kg_tail
kg_sp_10:
    s_cmp_lg_u32 s33, 1
    s_cbranch_scc1 kg_nout2_16
    s_setprio 3
    v_lshrrev_b32 v2, 4, v1
    v_lshlrev_b32 v2, 3, v2
    v_bfe_u32 v3, v1, 2, 2
    v_add_u32 v2, v2, v3
    v_lshlrev_b32 v2, 7, v2
    v_and_b32 v3, 3, v1
    v_lshlrev_b32 v3, 3, v3
    v_add_u32 v2, v2, v3
    v_add_u32 v2, 153856, v2
    ds_read_b64_tr_b16 v[40:41], v2 offset:0
    ds_read_b64_tr_b16 v[42:43], v2 offset:512
    ds_read_b64_tr_b16 v[44:45], v2 offset:32
    ds_read_b64_tr_b16 v[46:47], v2 offset:544
    ds_read_b64_tr_b16 v[48:49], v2 offset:64
    ds_read_b64_tr_b16 v[50:51], v2 offset:576
    ds_read_b64_tr_b16 v[52:53], v2 offset:96
    ds_read_b64_tr_b16 v[54:55], v2 offset:608
    ds_read_b64_tr_b16 v[56:57], v2 offset:4096
    ds_read_b64_tr_b16 v[58:59], v2 offset:4608
    ds_read_b64_tr_b16 v[60:61], v2 offset:4128
    ds_read_b64_tr_b16 v[62:63], v2 offset:4640
    ds_read_b64_tr_b16 v[64:65], v2 offset:4160
    ds_read_b64_tr_b16 v[66:67], v2 offset:4672
    ds_read_b64_tr_b16 v[68:69], v2 offset:4192
    ds_read_b64_tr_b16 v[70:71], v2 offset:4704
    v_and_b32 v3, 15, v1
    v_lshlrev_b32 v3, 12, v3
    v_lshrrev_b32 v4, 4, v1
    v_lshlrev_b32 v4, 4, v4
    v_add_u32 v3, v3, v4
    s_and_b32 s31, s2, 7
    s_lshl_b32 s31, s31, 18
    s_lshr_b32 s32, s2, 3
    s_lshl_b32 s32, s32, 7
    s_add_u32 s31, s31, s32
    s_add_u32 s31, s31, 9437184
    s_waitcnt lgkmcnt(0)
    s_add_u32 s32, s31, 0
    buffer_store_dwordx4 v[40:43], v3, s[20:23], s32 offen sc1
    s_add_u32 s32, s31, 65536
    buffer_store_dwordx4 v[44:47], v3, s[20:23], s32 offen sc1
    s_add_u32 s32, s31, 131072
    buffer_store_dwordx4 v[48:51], v3, s[20:23], s32 offen sc1
    s_add_u32 s32, s31, 196608
    buffer_store_dwordx4 v[52:55], v3, s[20:23], s32 offen sc1
    s_add_u32 s32, s31, 64
    buffer_store_dwordx4 v[56:59], v3, s[20:23], s32 offen sc1
    s_add_u32 s32, s31, 65600
    buffer_store_dwordx4 v[60:63], v3, s[20:23], s32 offen sc1
    s_add_u32 s32, s31, 131136
    buffer_store_dwordx4 v[64:67], v3, s[20:23], s32 offen sc1
    s_add_u32 s32, s31, 196672
    buffer_store_dwordx4 v[68:71], v3, s[20:23], s32 offen sc1
    v_mov_b32 v8, 0
    buffer_load_dword v9, v8, s[16:19], 0 offen sc1
    s_setprio 0
    s_nop 1
kg_nout2_16:
    s_branch kg_spb_11
kg_sp_12:
    s_cmp_lg_u32 s33, 1
    s_cbranch_scc1 kg_nopub_17
    s_waitcnt vmcnt(0)
    v_readfirstlane_b32 s32, v9
    s_nop 2
    s_cmp_lg_u32 s32, 0
    s_cbranch_scc1 kg_rdy_18
    s_mov_b32 s36, 0
    v_mov_b32 v2, 0
    s_mov_b32 s35, 0
spg_19:
    buffer_load_dword v3, v2, s[16:19], s36 offen sc1
    s_waitcnt vmcnt(0)
    v_readfirstlane_b32 s32, v3
    s_add_u32 s35, s35, 1
    s_nop 2
    s_cmp_ge_u32 s32, 1
    s_cbranch_scc1 spgd_20
    s_cmp_ge_u32 s35, 0x80000
    s_cbranch_scc1 spgd_20
    s_sleep 1
    s_branch spg_19
spgd_20:
kg_rdy_18:
    s_and_b32 s31, s2, 7
    s_add_u32 s31, s31, 8
    s_lshl_b32 s31, s31, 12
    s_add_u32 s31, s31, 12582912
    v_mov_b32 v2, 0
    v_mov_b32 v3, 1
    s_mov_b64 exec, 1
    buffer_atomic_add v3, v2, s[20:23], s31 offen
    s_mov_b64 exec, -1
kg_nopub_17:
    s_branch kg_spb_13
kg_sp_14:
    s_and_b32 s37, s2, 7
    s_add_u32 s37, s37, 8
    s_lshl_b32 s37, s37, 12
    s_add_u32 s37, s37, 12582912
    v_mov_b32 v8, 0
    buffer_load_dword v9, v8, s[20:23], s37 offen sc1
    s_branch kg_spb_15
kg_tail:
    v_mov_b32 v2, s34
    v_mov_b32 v3, s13
    v_mov_b32 v4, 0
    s_nop 4
    v_add_f32 v24, v24, v21
    ds_write_b32 v136, v24
    ds_write_b32 v137, v25
    ds_write_b32 v138, v26
    ds_write_b32 v139, v27
    s_mov_b32 exec_lo, 0
    ds_write_b32 v136, v28 offset:512
    ds_write_b32 v137, v29 offset:512
    ds_write_b32 v138, v30 offset:512
    ds_write_b32 v139, v31 offset:512
    ds_write_b32 v136, v32 offset:1024
    ds_write_b32 v137, v33 offset:1024
    ds_write_b32 v138, v34 offset:1024
    ds_write_b32 v139, v35 offset:1024
    ds_write_b32 v136, v36 offset:1536
    ds_write_b32 v137, v37 offset:1536
    ds_write_b32 v138, v38 offset:1536
    ds_write_b32 v139, v39 offset:1536
    s_brev_b32 exec_hi, 1
    ds_write_b32 v2, v22 offset:5636
    ds_write_b32 v2, v4 offset:5680
    s_mov_b64 exec, -1
    v_add_u32_sdwa v64, v140, v3 dst_sel:DWORD dst_unused:UNUSED_PAD src0_sel:WORD_0 src1_sel:DWORD
    v_add_u32_sdwa v75, v140, v3 dst_sel:DWORD dst_unused:UNUSED_PAD src0_sel:WORD_1 src1_sel:DWORD
    v_add_u32_sdwa v65, v141, v3 dst_sel:DWORD dst_unused:UNUSED_PAD src0_sel:WORD_0 src1_sel:DWORD
    v_add_u32_sdwa v76, v141, v3 dst_sel:DWORD dst_unused:UNUSED_PAD src0_sel:WORD_1 src1_sel:DWORD
    v_add_u32_sdwa v66, v142, v3 dst_sel:DWORD dst_unused:UNUSED_PAD src0_sel:WORD_0 src1_sel:DWORD
    v_add_u32_sdwa v77, v142, v3 dst_sel:DWORD dst_unused:UNUSED_PAD src0_sel:WORD_1 src1_sel:DWORD
    v_add_u32_sdwa v67, v143, v3 dst_sel:DWORD dst_unused:UNUSED_PAD src0_sel:WORD_0 src1_sel:DWORD
    v_add_u32_sdwa v78, v143, v3 dst_sel:DWORD dst_unused:UNUSED_PAD src0_sel:WORD_1 src1_sel:DWORD
    v_add_u32_sdwa v68, v144, v3 dst_sel:DWORD dst_unused:UNUSED_PAD src0_sel:WORD_0 src1_sel:DWORD
    v_add_u32_sdwa v79, v144, v3 dst_sel:DWORD dst_unused:UNUSED_PAD src0_sel:WORD_1 src1_sel:DWORD
    v_add_u32_sdwa v69, v145, v3 dst_sel:DWORD dst_unused:UNUSED_PAD src0_sel:WORD_0 src1_sel:DWORD
    v_add_u32_sdwa v80, v145, v3 dst_sel:DWORD dst_unused:UNUSED_PAD src0_sel:WORD_1 src1_sel:DWORD
    v_add_u32_sdwa v70, v146, v3 dst_sel:DWORD dst_unused:UNUSED_PAD src0_sel:WORD_0 src1_sel:DWORD
    v_add_u32_sdwa v81, v146, v3 dst_sel:DWORD dst_unused:UNUSED_PAD src0_sel:WORD_1 src1_sel:DWORD
    v_add_u32_sdwa v71, v147, v3 dst_sel:DWORD dst_unused:UNUSED_PAD src0_sel:WORD_0 src1_sel:DWORD
    v_add_u32_sdwa v82, v147, v3 dst_sel:DWORD dst_unused:UNUSED_PAD src0_sel:WORD_1 src1_sel:DWORD
    v_add_u32_sdwa v72, v148, v3 dst_sel:DWORD dst_unused:UNUSED_PAD src0_sel:WORD_0 src1_sel:DWORD
    v_add_u32_sdwa v83, v148, v3 dst_sel:DWORD dst_unused:UNUSED_PAD src0_sel:WORD_1 src1_sel:DWORD
    v_add_u32_sdwa v73, v149, v3 dst_sel:DWORD dst_unused:UNUSED_PAD src0_sel:WORD_0 src1_sel:DWORD
    v_add_u32_sdwa v84, v149, v3 dst_sel:DWORD dst_unused:UNUSED_PAD src0_sel:WORD_1 src1_sel:DWORD
    v_add_u32_sdwa v74, v150, v3 dst_sel:DWORD dst_unused:UNUSED_PAD src0_sel:WORD_0 src1_sel:DWORD
    v_add_u32_sdwa v85, v150, v3 dst_sel:DWORD dst_unused:UNUSED_PAD src0_sel:WORD_1 src1_sel:DWORD
    s_waitcnt lgkmcnt(0)
    s_barrier
    ds_read_b32 v40, v64
    ds_read_b32 v104, v64 offset:5696
    ds_read_b32 v41, v65
    ds_read_b32 v105, v65 offset:5696
    ds_read_b32 v42, v66
    ds_read_b32 v106, v66 offset:5696
    ds_read_b32 v43, v67
    ds_read_b32 v107, v67 offset:5696
    ds_read_b32 v44, v68
    ds_read_b32 v108, v68 offset:5696
    ds_read_b32 v45, v69
    ds_read_b32 v109, v69 offset:5696
    ds_read_b32 v46, v70
    ds_read_b32 v110, v70 offset:5696
    ds_read_b32 v47, v71
    ds_read_b32 v111, v71 offset:5696
    ds_read_b32 v48, v72
    ds_read_b32 v112, v72 offset:5696
    ds_read_b32 v49, v73
    ds_read_b32 v113, v73 offset:5696
    ds_read_b32 v50, v74
    ds_read_b32 v114, v74 offset:5696
    ds_read_b32 v51, v75
    ds_read_b32 v115, v75 offset:5696
    ds_read_b32 v52, v76
    ds_read_b32 v116, v76 offset:5696
    ds_read_b32 v53, v77
    ds_read_b32 v117, v77 offset:5696
    ds_read_b32 v54, v78
    ds_read_b32 v118, v78 offset:5696
    ds_read_b32 v55, v79
    ds_read_b32 v119, v79 offset:5696
    ds_read_b32 v56, v80
    ds_read_b32 v120, v80 offset:5696
    ds_read_b32 v57, v81
    ds_read_b32 v121, v81 offset:5696
    ds_read_b32 v58, v82
    ds_read_b32 v122, v82 offset:5696
    ds_read_b32 v59, v83
    ds_read_b32 v123, v83 offset:5696
    ds_read_b32 v60, v84
    ds_read_b32 v124, v84 offset:5696
    ds_read_b32 v61, v85
    ds_read_b32 v125, v85 offset:5696
    s_waitcnt vmcnt(0)
    v_readfirstlane_b32 s32, v9
    s_nop 2
    s_cmp_ge_u32 s32, 32
    s_cbranch_scc1 kg_urdy_21
    v_mov_b32 v6, 0
    s_mov_b32 s35, 0
spg_22:
    buffer_load_dword v7, v6, s[20:23], s37 offen sc1
    s_waitcnt vmcnt(0)
    v_readfirstlane_b32 s32, v7
    s_add_u32 s35, s35, 1
    s_nop 2
    s_cmp_ge_u32 s32, 32
    s_cbranch_scc1 spgd_23
    s_cmp_ge_u32 s35, 0x80000
    s_cbranch_scc1 spgd_23
    s_sleep 1
    s_branch spg_22
spgd_23:
kg_urdy_21:
    s_lshl_b32 s32, s29, 12
    s_add_u32 s32, s32, 9437184
    v_lshlrev_b32 v2, 4, v1
    buffer_load_dwordx4 v[136:139], v2, s[20:23], s32 offen sc1
    buffer_load_dwordx4 v[140:143], v2, s[20:23], s32 offen offset:1024 sc1
    buffer_load_dwordx4 v[144:147], v2, s[20:23], s32 offen offset:2048 sc1
    buffer_load_dwordx4 v[148:151], v2, s[20:23], s32 offen offset:3072 sc1
    s_mul_i32 s35, s28, 8320
    v_lshlrev_b32 v19, 1, v14
    v_add_u32 v19, s35, v19
    v_add_u32 v18, 105856, v19
    v_add_u32 v19, 137216, v19
    s_mul_i32 s36, s12, 4160
    s_add_u32 s36, s36, s35
    s_add_u32 s36, s36, 109952
    v_lshlrev_b32 v20, 2, v1
    v_add_u32 v20, s36, v20
    s_mov_b32 exec_lo, 0xffff
    s_mov_b32 exec_hi, 0
    ds_write_b32 v20, v4
    s_mov_b64 exec, -1
    s_waitcnt lgkmcnt(1)
    v_add_f32 v40, v40, v104
    v_add_f32 v41, v41, v105
    v_add_f32 v42, v42, v106
    v_add_f32 v43, v43, v107
    v_add_f32 v44, v44, v108
    v_add_f32 v45, v45, v109
    v_add_f32 v46, v46, v110
    v_add_f32 v47, v47, v111
    v_add_f32 v48, v48, v112
    v_add_f32 v49, v49, v113
    v_add_f32 v50, v50, v114
    v_add_f32 v51, v51, v115
    v_add_f32 v52, v52, v116
    v_add_f32 v53, v53, v117
    v_add_f32 v54, v54, v118
    v_add_f32 v55, v55, v119
    v_add_f32 v56, v56, v120
    v_add_f32 v57, v57, v121
    v_add_f32 v58, v58, v122
    v_add_f32 v59, v59, v123
    v_add_f32 v60, v60, v124
    v_add_f32 v61, v61, v125
    v_cvt_pk_bf16_f32 v88, v40, v41
    v_cvt_pk_bf16_f32 v89, v42, v43
    v_cvt_pk_bf16_f32 v90, v44, v45
    v_cvt_pk_bf16_f32 v91, v46, v47
    ds_write_b128 v19, v[88:91] offset:0
    v_cvt_pk_bf16_f32 v92, v41, v42
    v_cvt_pk_bf16_f32 v93, v43, v44
    v_cvt_pk_bf16_f32 v94, v45, v46
    v_cvt_pk_bf16_f32 v95, v47, v48
    ds_write_b128 v19, v[92:95] offset:4160
    v_cvt_pk_bf16_f32 v96, v42, v43
    v_cvt_pk_bf16_f32 v97, v44, v45
    v_cvt_pk_bf16_f32 v98, v46, v47
    v_cvt_pk_bf16_f32 v99, v48, v49
    ds_write_b128 v18, v[96:99] offset:0
    v_cvt_pk_bf16_f32 v100, v43, v44
    v_cvt_pk_bf16_f32 v101, v45, v46
    v_cvt_pk_bf16_f32 v102, v47, v48
    v_cvt_pk_bf16_f32 v103, v49, v50
    ds_write_b128 v18, v[100:103] offset:4160
    v_cvt_pk_bf16_f32 v88, v51, v52
    v_cvt_pk_bf16_f32 v89, v53, v54
    v_cvt_pk_bf16_f32 v90, v55, v56
    v_cvt_pk_bf16_f32 v91, v57, v58
    ds_write_b128 v19, v[88:91] offset:1024
    v_cvt_pk_bf16_f32 v92, v52, v53
    v_cvt_pk_bf16_f32 v93, v54, v55
    v_cvt_pk_bf16_f32 v94, v56, v57
    v_cvt_pk_bf16_f32 v95, v58, v59
    ds_write_b128 v19, v[92:95] offset:5184
    v_cvt_pk_bf16_f32 v96, v53, v54
    v_cvt_pk_bf16_f32 v97, v55, v56
    v_cvt_pk_bf16_f32 v98, v57, v58
    v_cvt_pk_bf16_f32 v99, v59, v60
    ds_write_b128 v18, v[96:99] offset:1024
    v_cvt_pk_bf16_f32 v100, v54, v55
    v_cvt_pk_bf16_f32 v101, v56, v57
    v_cvt_pk_bf16_f32 v102, v58, v59
    v_cvt_pk_bf16_f32 v103, v60, v61
    ds_write_b128 v18, v[100:103] offset:5184
    s_waitcnt lgkmcnt(0)
    v_mov_b32 v112, 163328
    v_mov_b32 v113, 1
    s_mov_b64 exec, 1
    ds_add_u32 v112, v113 offset:20
    s_mov_b64 exec, -1
    s_branch p2_entry
p2_entry:
    s_load_dwordx2 s[4:5], s[0:1], 96
    s_load_dwordx2 s[8:9], s[0:1], 80
    s_load_dwordx2 s[10:11], s[0:1], 88
    v_lshrrev_b32 v2, 6, v0
    s_and_b32 s28, s2, 7
    s_lshr_b32 s29, s2, 3
    v_readfirstlane_b32 s24, v2
    s_lshl_b32 s25, s28, 2
    s_and_b32 s30, s29, 3
    s_add_u32 s25, s25, s30
    s_lshr_b32 s26, s29, 2
    s_lshl_b32 s27, s28, 5
    s_add_u32 s27, s27, s29
    s_waitcnt lgkmcnt(0)
    s_mov_b32 s12, s4
    s_and_b32 s13, s5, 0xffff
    s_mov_b32 s14, 0x10000000
    s_mov_b32 s15, 0x20000
    s_mov_b32 s20, s8
    s_and_b32 s21, s9, 0xffff
    s_mov_b32 s22, 0x400000
    s_mov_b32 s23, 0x20000
    s_mov_b32 s44, s10
    s_and_b32 s45, s11, 0xffff
    s_mov_b32 s46, 0x100
    s_mov_b32 s47, 0x20000
    s_cmp_ge_u32 s24, 8
    s_cbranch_scc1 k2_conv
k2_attn:
    s_lshl_b32 s28, s25, 6
    s_lshl_b32 s29, s26, 3
    s_add_u32 s29, s29, s24
    s_add_u32 s32, s28, s29
    s_lshl_b32 s32, s32, 10
    v_lshlrev_b32 v104, 4, v1
    v_mov_b32 v112, 163328
    v_mov_b32 v113, 1
    s_cmp_lg_u32 s24, 0
    s_cbranch_scc1 at_nosig_24
    s_mov_b32 s35, 0
spl_25:
    ds_read_b32 v2, v112 offset:24
    s_waitcnt lgkmcnt(0)
    v_readfirstlane_b32 s34, v2
    s_add_u32 s35, s35, 1
    s_nop 2
    s_cmp_ge_u32 s34, 4
    s_cbranch_scc1 spld_26
    s_cmp_ge_u32 s35, 0x400000
    s_cbranch_scc1 spld_26
    s_sleep 1
    s_branch spl_25
spld_26:
    s_and_b32 s33, s2, 7
    s_lshr_b32 s34, s33, 2
    s_lshl_b32 s34, s34, 2
    s_lshr_b32 s35, s2, 6
    s_add_u32 s34, s34, s35
    s_and_b32 s33, s33, 3
    s_lshl_b32 s33, s33, 1
    s_bfe_u32 s35, s2, 0x10005
    s_add_u32 s33, s33, s35
    s_lshl_b32 s34, s34, 3
    s_add_u32 s33, s33, s34
    s_add_u32 s33, s33, 96
    s_lshl_b32 s33, s33, 12
    s_add_u32 s33, s33, 12582912
    v_mov_b32 v2, 0
    v_mov_b32 v3, 1
    s_mov_b64 exec, 1
    buffer_atomic_add v3, v2, s[12:15], s33 offen
    s_mov_b64 exec, -1
at_nosig_24:
    s_cmp_ge_u32 s24, 4
    s_cbranch_scc1 at_noconst_27
    v_mul_u32_u24 v6, 1120, v1
    s_lshr_b32 s33, s24, 1
    s_lshl_b32 s33, s33, 6
    s_and_b32 s34, s24, 1
    s_lshl_b32 s35, s34, 4
    s_add_u32 s33, s33, s35
    s_add_u32 s33, s33, 66560
    v_add_u32 v6, s33, v6
    s_cmp_eq_u32 s34, 0
    s_cselect_b32 s33, 0x3f803f80, 0
    v_mov_b32 v8, s33
    v_mov_b32 v9, s33
    v_mov_b32 v10, s33
    v_mov_b32 v11, s33
    s_mov_b32 exec_hi, 0
    ds_write_b128 v6, v[8:11]
    s_mov_b64 exec, -1
at_noconst_27:
    s_cmp_lg_u32 s24, 4
    s_cbranch_scc1 at_nopoll_28
    s_lshr_b32 s33, s25, 2
    s_lshl_b32 s33, s33, 12
    s_add_u32 s33, s33, 12582912
    v_mov_b32 v2, 0
    s_mov_b32 s35, 0
spg_30:
    buffer_load_dword v3, v2, s[12:15], s33 offen sc1
    s_waitcnt vmcnt(0)
    v_readfirstlane_b32 s34, v3
    s_add_u32 s35, s35, 1
    s_nop 2
    s_cmp_ge_u32 s34, 32
    s_cbranch_scc1 spgd_31
    s_cmp_ge_u32 s35, 0x80000
    s_cbranch_scc1 spgd_31
    s_sleep 1
    s_branch spg_30
spgd_31:
    s_mov_b64 exec, 1
    ds_add_u32 v112, v113 offset:0
    s_mov_b64 exec, -1
    s_branch at_go_29
at_nopoll_28:
    s_mov_b32 s35, 0
spl_32:
    ds_read_b32 v2, v112 offset:0
    s_waitcnt lgkmcnt(0)
    v_readfirstlane_b32 s34, v2
    s_add_u32 s35, s35, 1
    s_nop 2
    s_cmp_ge_u32 s34, 1
    s_cbranch_scc1 spld_33
    s_cmp_ge_u32 s35, 0x400000
    s_cbranch_scc1 spld_33
    s_sleep 1
    s_branch spl_32
spld_33:
at_go_29:
    s_lshl_b32 s35, s24, 10
    s_mul_i32 s36, s24, 1120
    s_add_u32 s33, s24, 0
    s_add_u32 s33, s33, s28
    s_lshl_b32 s33, s33, 10
    s_add_u32 s34, s33, 4194304
    s_add_u32 s33, s33, 2097152
    s_add_u32 m0, s35, 0
    s_nop 0
    buffer_load_dwordx4 v104, s[12:15], s33 offen sc1 lds
    s_add_u32 m0, s36, 65536
    s_nop 0
    buffer_load_dwordx4 v104, s[12:15], s34 offen sc1 lds
    s_add_u32 s33, s24, 8
    s_add_u32 s33, s33, s28
    s_lshl_b32 s33, s33, 10
    s_add_u32 s34, s33, 4194304
    s_add_u32 s33, s33, 2097152
    s_add_u32 m0, s35, 8192
    s_nop 0
    buffer_load_dwordx4 v104, s[12:15], s33 offen sc1 lds
    s_add_u32 m0, s36, 74496
    s_nop 0
    buffer_load_dwordx4 v104, s[12:15], s34 offen sc1 lds
    s_cmp_lg_u32 s24, 5
    s_cbranch_scc1 at_nopollq_34
    s_lshr_b32 s33, s25, 2
    s_lshl_b32 s33, s33, 3
    s_add_u32 s33, s33, s26
    s_add_u32 s33, s33, 96
    s_lshl_b32 s33, s33, 12
    s_add_u32 s33, s33, 12582912
    v_mov_b32 v2, 0
    s_mov_b32 s37, 0
spg_36:
    buffer_load_dword v3, v2, s[12:15], s33 offen sc1
    s_waitcnt vmcnt(0)
    v_readfirstlane_b32 s34, v3
    s_add_u32 s37, s37, 1
    s_nop 2
    s_cmp_ge_u32 s34, 4
    s_cbranch_scc1 spgd_37
    s_cmp_ge_u32 s37, 0x80000
    s_cbranch_scc1 spgd_37
    s_sleep 1
    s_branch spg_36
spgd_37:
    s_mov_b64 exec, 1
    ds_add_u32 v112, v113 offset:32
    s_mov_b64 exec, -1
    s_branch at_goq_35
at_nopollq_34:
    s_mov_b32 s37, 0
spl_38:
    ds_read_b32 v2, v112 offset:32
    s_waitcnt lgkmcnt(0)
    v_readfirstlane_b32 s34, v2
    s_add_u32 s37, s37, 1
    s_nop 2
    s_cmp_ge_u32 s34, 1
    s_cbranch_scc1 spld_39
    s_cmp_ge_u32 s37, 0x400000
    s_cbranch_scc1 spld_39
    s_sleep 1
    s_branch spl_38
spld_39:
at_goq_35:
    buffer_load_dwordx4 v[4:7], v104, s[12:15], s32 offen sc1
    v_and_b32 v106, 31, v1
    v_lshrrev_b32 v107, 5, v1
    v_lshlrev_b32 v107, 8, v107
    v_lshl_add_u32 v107, v106, 4, v107
    v_mov_b32 v108, 1040
    v_mov_b32 v109, 1104
    v_subrev_u32 v110, 20, v106
    v_cmp_gt_u32 vcc, 8, v110
    s_nop 1
    v_cndmask_b32 v108, v108, v109, vcc
    v_cmp_eq_u32 vcc, 16, v106
    v_mov_b32 v109, 1024
    s_nop 0
    v_cndmask_b32 v108, v108, v109, vcc
    v_cmp_eq_u32 vcc, 20, v106
    v_mov_b32 v109, 1088
    s_nop 0
    v_cndmask_b32 v108, v108, v109, vcc
    v_add_u32 v109, 512, v107
    v_cmp_gt_u32 vcc, 16, v106
    s_nop 1
    v_cndmask_b32 v110, v108, v107, vcc
    v_cndmask_b32 v111, v108, v109, vcc
    v_add_u32 v110, 65536, v110
    v_add_u32 v111, 65536, v111
    s_waitcnt vmcnt(0) lgkmcnt(0)
    s_mov_b64 exec, 1
    ds_add_u32 v112, v113 offset:4
    s_mov_b64 exec, -1
    s_mov_b32 s33, 0
spl_40:
    ds_read_b32 v2, v112 offset:4
    s_waitcnt lgkmcnt(0)
    v_readfirstlane_b32 s34, v2
    s_add_u32 s33, s33, 1
    s_nop 2
    s_cmp_ge_u32 s34, 8
    s_cbranch_scc1 spld_41
    s_cmp_ge_u32 s33, 0x400000
    s_cbranch_scc1 spld_41
    s_sleep 1
    s_branch spl_40
spld_41:
    s_mov_b32 s33, 0
spl_42:
    ds_read_b32 v2, v112 offset:20
    s_waitcnt lgkmcnt(0)
    v_readfirstlane_b32 s34, v2
    s_add_u32 s33, s33, 1
    s_nop 2
    s_cmp_ge_u32 s34, 4
    s_cbranch_scc1 spld_43
    s_cmp_ge_u32 s33, 0x400000
    s_cbranch_scc1 spld_43
    s_sleep 1
    s_branch spl_42
spld_43:
    v_mov_b32 v2, v104
    v_mov_b32 v3, v110
    v_mov_b32 v105, v111
    ds_read_b128 v[8:11], v2
    ds_read_b128 v[12:15], v2 offset:1024
    ds_read_b128 v[16:19], v3
    ds_read_b128 v[24:27], v105
    v_mov_b32 v40, 0
    v_mov_b32 v41, 0
    v_mov_b32 v42, 0
    v_mov_b32 v43, 0
    v_mov_b32 v44, 0
    v_mov_b32 v45, 0
    v_mov_b32 v46, 0
    v_mov_b32 v47, 0
    v_mov_b32 v48, 0
    v_mov_b32 v49, 0
    v_mov_b32 v50, 0
    v_mov_b32 v51, 0
    v_mov_b32 v52, 0
    v_mov_b32 v53, 0
    v_mov_b32 v54, 0
    v_mov_b32 v55, 0
    v_mov_b32 v32, 0
    v_mov_b32 v33, 0
    v_mov_b32 v34, 0
    v_mov_b32 v35, 0
    v_mov_b32 v36, 0
    v_mov_b32 v37, 0
    v_mov_b32 v38, 0
    v_mov_b32 v39, 0
    v_mov_b32 v28, 0
    v_mov_b32 v29, 0
    v_mov_b32 v30, 0
    v_mov_b32 v31, 0
    s_waitcnt lgkmcnt(3)
    v_mfma_f32_32x32x16_bf16 v[56:71], v[8:11], v[4:7], 0
    s_nop 11
    s_add_u32 s33, s24, 16
    s_add_u32 s33, s33, s28
    s_lshl_b32 s33, s33, 10
    s_add_u32 s34, s33, 4194304
    s_add_u32 s33, s33, 2097152
    s_add_u32 m0, s35, 16384
    s_nop 0
    buffer_load_dwordx4 v104, s[12:15], s33 offen sc1 lds
    s_add_u32 m0, s36, 83456
    s_nop 0
    buffer_load_dwordx4 v104, s[12:15], s34 offen sc1 lds
    s_waitcnt lgkmcnt(0)
    v_exp_f32 v56, v56
    v_exp_f32 v57, v57
    v_mfma_f32_32x32x16_bf16 v[40:55], v[28:31], v[36:39], v[40:55]
    ds_read_b128 v[28:31], v105 offset:1120
    v_exp_f32 v58, v58
    v_exp_f32 v59, v59
    v_exp_f32 v60, v60
    v_exp_f32 v61, v61
    v_exp_f32 v62, v62
    v_mfma_f32_32x32x16_bf16 v[72:87], v[12:15], v[4:7], 0
    ds_read_b128 v[8:11], v2 offset:2048
    v_exp_f32 v63, v63
    v_exp_f32 v64, v64
    v_cvt_pk_bf16_f32 v32, v56, v57
    v_cvt_pk_bf16_f32 v33, v58, v59
    v_cvt_pk_bf16_f32 v34, v60, v61
    v_cvt_pk_bf16_f32 v35, v62, v63
    v_exp_f32 v65, v65
    v_exp_f32 v66, v66
    v_exp_f32 v67, v67
    v_mfma_f32_32x32x16_bf16 v[40:55], v[16:19], v[32:35], v[40:55]
    ds_read_b128 v[20:23], v3 offset:1120
    v_exp_f32 v68, v68
    v_exp_f32 v69, v69
    v_exp_f32 v70, v70
    v_exp_f32 v71, v71
    v_cvt_pk_bf16_f32 v36, v64, v65
    v_cvt_pk_bf16_f32 v37, v66, v67
    v_cvt_pk_bf16_f32 v38, v68, v69
    v_cvt_pk_bf16_f32 v39, v70, v71
    s_add_u32 s33, s24, 24
    s_add_u32 s33, s33, s28
    s_lshl_b32 s33, s33, 10
    s_add_u32 s34, s33, 4194304
    s_add_u32 s33, s33, 2097152
    s_add_u32 m0, s35, 24576
    s_nop 0
    buffer_load_dwordx4 v104, s[12:15], s33 offen sc1 lds
    s_add_u32 m0, s36, 92416
    s_nop 0
    buffer_load_dwordx4 v104, s[12:15], s34 offen sc1 lds
    s_waitcnt lgkmcnt(0)
    v_exp_f32 v72, v72
    v_exp_f32 v73, v73
    v_mfma_f32_32x32x16_bf16 v[40:55], v[24:27], v[36:39], v[40:55]
    ds_read_b128 v[24:27], v105 offset:2240
    v_exp_f32 v74, v74
    v_exp_f32 v75, v75
    v_exp_f32 v76, v76
    v_exp_f32 v77, v77
    v_exp_f32 v78, v78
    v_mfma_f32_32x32x16_bf16 v[56:71], v[8:11], v[4:7], 0
    ds_read_b128 v[12:15], v2 offset:3072
    v_exp_f32 v79, v79
    v_exp_f32 v80, v80
    v_cvt_pk_bf16_f32 v32, v72, v73
    v_cvt_pk_bf16_f32 v33, v74, v75
    v_cvt_pk_bf16_f32 v34, v76, v77
    v_cvt_pk_bf16_f32 v35, v78, v79
    v_exp_f32 v81, v81
    v_exp_f32 v82, v82
    v_exp_f32 v83, v83
    v_mfma_f32_32x32x16_bf16 v[40:55], v[20:23], v[32:35], v[40:55]
    ds_read_b128 v[16:19], v3 offset:2240
    v_exp_f32 v84, v84
    v_exp_f32 v85, v85
    v_exp_f32 v86, v86
    v_exp_f32 v87, v87
    v_cvt_pk_bf16_f32 v36, v80, v81
    v_cvt_pk_bf16_f32 v37, v82, v83
    v_cvt_pk_bf16_f32 v38, v84, v85
    v_cvt_pk_bf16_f32 v39, v86, v87
    s_waitcnt lgkmcnt(0)
    v_exp_f32 v56, v56
    v_exp_f32 v57, v57
    v_mfma_f32_32x32x16_bf16 v[40:55], v[28:31], v[36:39], v[40:55]
    ds_read_b128 v[28:31], v105 offset:3360
    v_exp_f32 v58, v58
    v_exp_f32 v59, v59
    v_exp_f32 v60, v60
    v_exp_f32 v61, v61
    v_exp_f32 v62, v62
    v_mfma_f32_32x32x16_bf16 v[72:87], v[12:15], v[4:7], 0
    ds_read_b128 v[8:11], v2 offset:4096
    v_exp_f32 v63, v63
    v_exp_f32 v64, v64
    v_cvt_pk_bf16_f32 v32, v56, v57
    v_cvt_pk_bf16_f32 v33, v58, v59
    v_cvt_pk_bf16_f32 v34, v60, v61
    v_cvt_pk_bf16_f32 v35, v62, v63
    v_exp_f32 v65, v65
    v_exp_f32 v66, v66
    v_exp_f32 v67, v67
    v_mfma_f32_32x32x16_bf16 v[40:55], v[16:19], v[32:35], v[40:55]
    ds_read_b128 v[20:23], v3 offset:3360
    v_exp_f32 v68, v68
    v_exp_f32 v69, v69
    v_exp_f32 v70, v70
    v_exp_f32 v71, v71
    v_cvt_pk_bf16_f32 v36, v64, v65
    v_cvt_pk_bf16_f32 v37, v66, v67
    v_cvt_pk_bf16_f32 v38, v68, v69
    v_cvt_pk_bf16_f32 v39, v70, v71
    s_waitcnt lgkmcnt(0)
    v_exp_f32 v72, v72
    v_exp_f32 v73, v73
    v_mfma_f32_32x32x16_bf16 v[40:55], v[24:27], v[36:39], v[40:55]
    ds_read_b128 v[24:27], v105 offset:4480
    v_exp_f32 v74, v74
    v_exp_f32 v75, v75
    v_exp_f32 v76, v76
    v_exp_f32 v77, v77
    v_exp_f32 v78, v78
    v_mfma_f32_32x32x16_bf16 v[56:71], v[8:11], v[4:7], 0
    ds_read_b128 v[12:15], v2 offset:5120
    v_exp_f32 v79, v79
    v_exp_f32 v80, v80
    v_cvt_pk_bf16_f32 v32, v72, v73
    v_cvt_pk_bf16_f32 v33, v74, v75
    v_cvt_pk_bf16_f32 v34, v76, v77
    v_cvt_pk_bf16_f32 v35, v78, v79
    v_exp_f32 v81, v81
    v_exp_f32 v82, v82
    v_exp_f32 v83, v83
    v_mfma_f32_32x32x16_bf16 v[40:55], v[20:23], v[32:35], v[40:55]
    ds_read_b128 v[16:19], v3 offset:4480
    v_exp_f32 v84, v84
    v_exp_f32 v85, v85
    v_exp_f32 v86, v86
    v_exp_f32 v87, v87
    v_cvt_pk_bf16_f32 v36, v80, v81
    v_cvt_pk_bf16_f32 v37, v82, v83
    v_cvt_pk_bf16_f32 v38, v84, v85
    v_cvt_pk_bf16_f32 v39, v86, v87
    s_waitcnt lgkmcnt(0)
    v_exp_f32 v56, v56
    v_exp_f32 v57, v57
    v_mfma_f32_32x32x16_bf16 v[40:55], v[28:31], v[36:39], v[40:55]
    ds_read_b128 v[28:31], v105 offset:5600
    v_exp_f32 v58, v58
    v_exp_f32 v59, v59
    v_exp_f32 v60, v60
    v_exp_f32 v61, v61
    v_exp_f32 v62, v62
    v_mfma_f32_32x32x16_bf16 v[72:87], v[12:15], v[4:7], 0
    ds_read_b128 v[8:11], v2 offset:6144
    v_exp_f32 v63, v63
    v_exp_f32 v64, v64
    v_cvt_pk_bf16_f32 v32, v56, v57
    v_cvt_pk_bf16_f32 v33, v58, v59
    v_cvt_pk_bf16_f32 v34, v60, v61
    v_cvt_pk_bf16_f32 v35, v62, v63
    v_exp_f32 v65, v65
    v_exp_f32 v66, v66
    v_exp_f32 v67, v67
    v_mfma_f32_32x32x16_bf16 v[40:55], v[16:19], v[32:35], v[40:55]
    ds_read_b128 v[20:23], v3 offset:5600
    v_exp_f32 v68, v68
    v_exp_f32 v69, v69
    v_exp_f32 v70, v70
    v_exp_f32 v71, v71
    v_cvt_pk_bf16_f32 v36, v64, v65
    v_cvt_pk_bf16_f32 v37, v66, v67
    v_cvt_pk_bf16_f32 v38, v68, v69
    v_cvt_pk_bf16_f32 v39, v70, v71
    s_waitcnt lgkmcnt(0)
    v_exp_f32 v72, v72
    v_exp_f32 v73, v73
    v_mfma_f32_32x32x16_bf16 v[40:55], v[24:27], v[36:39], v[40:55]
    ds_read_b128 v[24:27], v105 offset:6720
    v_exp_f32 v74, v74
    v_exp_f32 v75, v75
    v_exp_f32 v76, v76
    v_exp_f32 v77, v77
    v_exp_f32 v78, v78
    v_mfma_f32_32x32x16_bf16 v[56:71], v[8:11], v[4:7], 0
    ds_read_b128 v[12:15], v2 offset:7168
    v_exp_f32 v79, v79
    v_exp_f32 v80, v80
    v_cvt_pk_bf16_f32 v32, v72, v73
    v_cvt_pk_bf16_f32 v33, v74, v75
    v_cvt_pk_bf16_f32 v34, v76, v77
    v_cvt_pk_bf16_f32 v35, v78, v79
    v_exp_f32 v81, v81
    v_exp_f32 v82, v82
    v_exp_f32 v83, v83
    v_mfma_f32_32x32x16_bf16 v[40:55], v[20:23], v[32:35], v[40:55]
    ds_read_b128 v[16:19], v3 offset:6720
    v_exp_f32 v84, v84
    v_exp_f32 v85, v85
    v_exp_f32 v86, v86
    v_exp_f32 v87, v87
    v_cvt_pk_bf16_f32 v36, v80, v81
    v_cvt_pk_bf16_f32 v37, v82, v83
    v_cvt_pk_bf16_f32 v38, v84, v85
    v_cvt_pk_bf16_f32 v39, v86, v87
    s_waitcnt lgkmcnt(0)
    v_exp_f32 v56, v56
    v_exp_f32 v57, v57
    v_mfma_f32_32x32x16_bf16 v[40:55], v[28:31], v[36:39], v[40:55]
    ds_read_b128 v[28:31], v105 offset:7840
    v_exp_f32 v58, v58
    v_exp_f32 v59, v59
    v_exp_f32 v60, v60
    v_exp_f32 v61, v61
    v_exp_f32 v62, v62
    v_mfma_f32_32x32x16_bf16 v[72:87], v[12:15], v[4:7], 0
    ds_read_b128 v[8:11], v2 offset:8192
    v_exp_f32 v63, v63
    v_exp_f32 v64, v64
    v_cvt_pk_bf16_f32 v32, v56, v57
    v_cvt_pk_bf16_f32 v33, v58, v59
    v_cvt_pk_bf16_f32 v34, v60, v61
    v_cvt_pk_bf16_f32 v35, v62, v63
    v_exp_f32 v65, v65
    v_exp_f32 v66, v66
    v_exp_f32 v67, v67
    v_mfma_f32_32x32x16_bf16 v[40:55], v[16:19], v[32:35], v[40:55]
    ds_read_b128 v[20:23], v3 offset:7840
    v_exp_f32 v68, v68
    v_exp_f32 v69, v69
    v_exp_f32 v70, v70
    v_exp_f32 v71, v71
    v_cvt_pk_bf16_f32 v36, v64, v65
    v_cvt_pk_bf16_f32 v37, v66, v67
    v_cvt_pk_bf16_f32 v38, v68, v69
    v_cvt_pk_bf16_f32 v39, v70, v71
    s_waitcnt lgkmcnt(0)
    v_exp_f32 v72, v72
    v_exp_f32 v73, v73
    v_mfma_f32_32x32x16_bf16 v[40:55], v[24:27], v[36:39], v[40:55]
    ds_read_b128 v[24:27], v105 offset:8960
    v_exp_f32 v74, v74
    v_exp_f32 v75, v75
    v_exp_f32 v76, v76
    v_exp_f32 v77, v77
    v_exp_f32 v78, v78
    v_mfma_f32_32x32x16_bf16 v[56:71], v[8:11], v[4:7], 0
    ds_read_b128 v[12:15], v2 offset:9216
    v_exp_f32 v79, v79
    v_exp_f32 v80, v80
    v_cvt_pk_bf16_f32 v32, v72, v73
    v_cvt_pk_bf16_f32 v33, v74, v75
    v_cvt_pk_bf16_f32 v34, v76, v77
    v_cvt_pk_bf16_f32 v35, v78, v79
    v_exp_f32 v81, v81
    v_exp_f32 v82, v82
    v_exp_f32 v83, v83
    v_mfma_f32_32x32x16_bf16 v[40:55], v[20:23], v[32:35], v[40:55]
    ds_read_b128 v[16:19], v3 offset:8960
    v_exp_f32 v84, v84
    v_exp_f32 v85, v85
    v_exp_f32 v86, v86
    v_exp_f32 v87, v87
    v_cvt_pk_bf16_f32 v36, v80, v81
    v_cvt_pk_bf16_f32 v37, v82, v83
    v_cvt_pk_bf16_f32 v38, v84, v85
    v_cvt_pk_bf16_f32 v39, v86, v87
    s_waitcnt vmcnt(0)
    s_mov_b64 exec, 1
    ds_add_u32 v112, v113 offset:8
    s_mov_b64 exec, -1
    s_waitcnt lgkmcnt(0)
    v_exp_f32 v56, v56
    v_exp_f32 v57, v57
    v_mfma_f32_32x32x16_bf16 v[40:55], v[28:31], v[36:39], v[40:55]
    ds_read_b128 v[28:31], v105 offset:10080
    v_exp_f32 v58, v58
    v_exp_f32 v59, v59
    v_exp_f32 v60, v60
    v_exp_f32 v61, v61
    v_exp_f32 v62, v62
    v_mfma_f32_32x32x16_bf16 v[72:87], v[12:15], v[4:7], 0
    ds_read_b128 v[8:11], v2 offset:10240
    v_exp_f32 v63, v63
    v_exp_f32 v64, v64
    v_cvt_pk_bf16_f32 v32, v56, v57
    v_cvt_pk_bf16_f32 v33, v58, v59
    v_cvt_pk_bf16_f32 v34, v60, v61
    v_cvt_pk_bf16_f32 v35, v62, v63
    v_exp_f32 v65, v65
    v_exp_f32 v66, v66
    v_exp_f32 v67, v67
    v_mfma_f32_32x32x16_bf16 v[40:55], v[16:19], v[32:35], v[40:55]
    ds_read_b128 v[20:23], v3 offset:10080
    v_exp_f32 v68, v68
    v_exp_f32 v69, v69
    v_exp_f32 v70, v70
    v_exp_f32 v71, v71
    v_cvt_pk_bf16_f32 v36, v64, v65
    v_cvt_pk_bf16_f32 v37, v66, v67
    v_cvt_pk_bf16_f32 v38, v68, v69
    v_cvt_pk_bf16_f32 v39, v70, v71
    s_waitcnt lgkmcnt(0)
    v_exp_f32 v72, v72
    v_exp_f32 v73, v73
    v_mfma_f32_32x32x16_bf16 v[40:55], v[24:27], v[36:39], v[40:55]
    ds_read_b128 v[24:27], v105 offset:11200
    v_exp_f32 v74, v74
    v_exp_f32 v75, v75
    v_exp_f32 v76, v76
    v_exp_f32 v77, v77
    v_exp_f32 v78, v78
    v_mfma_f32_32x32x16_bf16 v[56:71], v[8:11], v[4:7], 0
    ds_read_b128 v[12:15], v2 offset:11264
    v_exp_f32 v79, v79
    v_exp_f32 v80, v80
    v_cvt_pk_bf16_f32 v32, v72, v73
    v_cvt_pk_bf16_f32 v33, v74, v75
    v_cvt_pk_bf16_f32 v34, v76, v77
    v_cvt_pk_bf16_f32 v35, v78, v79
    v_exp_f32 v81, v81
    v_exp_f32 v82, v82
    v_exp_f32 v83, v83
    v_mfma_f32_32x32x16_bf16 v[40:55], v[20:23], v[32:35], v[40:55]
    ds_read_b128 v[16:19], v3 offset:11200
    v_exp_f32 v84, v84
    v_exp_f32 v85, v85
    v_exp_f32 v86, v86
    v_exp_f32 v87, v87
    v_cvt_pk_bf16_f32 v36, v80, v81
    v_cvt_pk_bf16_f32 v37, v82, v83
    v_cvt_pk_bf16_f32 v38, v84, v85
    v_cvt_pk_bf16_f32 v39, v86, v87
    s_waitcnt lgkmcnt(0)
    v_exp_f32 v56, v56
    v_exp_f32 v57, v57
    v_mfma_f32_32x32x16_bf16 v[40:55], v[28:31], v[36:39], v[40:55]
    ds_read_b128 v[28:31], v105 offset:12320
    v_exp_f32 v58, v58
    v_exp_f32 v59, v59
    v_exp_f32 v60, v60
    v_exp_f32 v61, v61
    v_exp_f32 v62, v62
    v_mfma_f32_32x32x16_bf16 v[72:87], v[12:15], v[4:7], 0
    ds_read_b128 v[8:11], v2 offset:12288
    v_exp_f32 v63, v63
    v_exp_f32 v64, v64
    v_cvt_pk_bf16_f32 v32, v56, v57
    v_cvt_pk_bf16_f32 v33, v58, v59
    v_cvt_pk_bf16_f32 v34, v60, v61
    v_cvt_pk_bf16_f32 v35, v62, v63
    v_exp_f32 v65, v65
    v_exp_f32 v66, v66
    v_exp_f32 v67, v67
    v_mfma_f32_32x32x16_bf16 v[40:55], v[16:19], v[32:35], v[40:55]
    ds_read_b128 v[20:23], v3 offset:12320
    v_exp_f32 v68, v68
    v_exp_f32 v69, v69
    v_exp_f32 v70, v70
    v_exp_f32 v71, v71
    v_cvt_pk_bf16_f32 v36, v64, v65
    v_cvt_pk_bf16_f32 v37, v66, v67
    v_cvt_pk_bf16_f32 v38, v68, v69
    v_cvt_pk_bf16_f32 v39, v70, v71
    s_waitcnt lgkmcnt(0)
    v_exp_f32 v72, v72
    v_exp_f32 v73, v73
    v_mfma_f32_32x32x16_bf16 v[40:55], v[24:27], v[36:39], v[40:55]
    ds_read_b128 v[24:27], v105 offset:13440
    v_exp_f32 v74, v74
    v_exp_f32 v75, v75
    v_exp_f32 v76, v76
    v_exp_f32 v77, v77
    v_exp_f32 v78, v78
    v_mfma_f32_32x32x16_bf16 v[56:71], v[8:11], v[4:7], 0
    ds_read_b128 v[12:15], v2 offset:13312
    v_exp_f32 v79, v79
    v_exp_f32 v80, v80
    v_cvt_pk_bf16_f32 v32, v72, v73
    v_cvt_pk_bf16_f32 v33, v74, v75
    v_cvt_pk_bf16_f32 v34, v76, v77
    v_cvt_pk_bf16_f32 v35, v78, v79
    v_exp_f32 v81, v81
    v_exp_f32 v82, v82
    v_exp_f32 v83, v83
    v_mfma_f32_32x32x16_bf16 v[40:55], v[20:23], v[32:35], v[40:55]
    ds_read_b128 v[16:19], v3 offset:13440
    v_exp_f32 v84, v84
    v_exp_f32 v85, v85
    v_exp_f32 v86, v86
    v_exp_f32 v87, v87
    v_cvt_pk_bf16_f32 v36, v80, v81
    v_cvt_pk_bf16_f32 v37, v82, v83
    v_cvt_pk_bf16_f32 v38, v84, v85
    v_cvt_pk_bf16_f32 v39, v86, v87
    ds_read_b32 v114, v112 offset:8
    s_waitcnt lgkmcnt(0)
    v_exp_f32 v56, v56
    v_exp_f32 v57, v57
    v_mfma_f32_32x32x16_bf16 v[40:55], v[28:31], v[36:39], v[40:55]
    ds_read_b128 v[28:31], v105 offset:14560
    v_exp_f32 v58, v58
    v_exp_f32 v59, v59
    v_exp_f32 v60, v60
    v_exp_f32 v61, v61
    v_exp_f32 v62, v62
    v_mfma_f32_32x32x16_bf16 v[72:87], v[12:15], v[4:7], 0
    ds_read_b128 v[8:11], v2 offset:14336
    v_exp_f32 v63, v63
    v_exp_f32 v64, v64
    v_cvt_pk_bf16_f32 v32, v56, v57
    v_cvt_pk_bf16_f32 v33, v58, v59
    v_cvt_pk_bf16_f32 v34, v60, v61
    v_cvt_pk_bf16_f32 v35, v62, v63
    v_exp_f32 v65, v65
    v_exp_f32 v66, v66
    v_exp_f32 v67, v67
    v_mfma_f32_32x32x16_bf16 v[40:55], v[16:19], v[32:35], v[40:55]
    ds_read_b128 v[20:23], v3 offset:14560
    v_exp_f32 v68, v68
    v_exp_f32 v69, v69
    v_exp_f32 v70, v70
    v_exp_f32 v71, v71
    v_cvt_pk_bf16_f32 v36, v64, v65
    v_cvt_pk_bf16_f32 v37, v66, v67
    v_cvt_pk_bf16_f32 v38, v68, v69
    v_cvt_pk_bf16_f32 v39, v70, v71
    s_waitcnt lgkmcnt(0)
    v_readfirstlane_b32 s34, v114
    s_nop 0
    s_cmp_lt_u32 s34, 8
    s_cbranch_scc1 at_spin_44
at_back_45:
    s_waitcnt lgkmcnt(0)
    v_exp_f32 v72, v72
    v_exp_f32 v73, v73
    v_mfma_f32_32x32x16_bf16 v[40:55], v[24:27], v[36:39], v[40:55]
    ds_read_b128 v[24:27], v105 offset:15680
    v_exp_f32 v74, v74
    v_exp_f32 v75, v75
    v_exp_f32 v76, v76
    v_exp_f32 v77, v77
    v_exp_f32 v78, v78
    v_mfma_f32_32x32x16_bf16 v[56:71], v[8:11], v[4:7], 0
    ds_read_b128 v[12:15], v2 offset:15360
    v_exp_f32 v79, v79
    v_exp_f32 v80, v80
    v_cvt_pk_bf16_f32 v32, v72, v73
    v_cvt_pk_bf16_f32 v33, v74, v75
    v_cvt_pk_bf16_f32 v34, v76, v77
    v_cvt_pk_bf16_f32 v35, v78, v79
    v_exp_f32 v81, v81
    v_exp_f32 v82, v82
    v_exp_f32 v83, v83
    v_mfma_f32_32x32x16_bf16 v[40:55], v[20:23], v[32:35], v[40:55]
    ds_read_b128 v[16:19], v3 offset:15680
    v_exp_f32 v84, v84
    v_exp_f32 v85, v85
    v_exp_f32 v86, v86
    v_exp_f32 v87, v87
    v_cvt_pk_bf16_f32 v36, v80, v81
    v_cvt_pk_bf16_f32 v37, v82, v83
    v_cvt_pk_bf16_f32 v38, v84, v85
    v_cvt_pk_bf16_f32 v39, v86, v87
    s_waitcnt lgkmcnt(0)
    v_exp_f32 v56, v56
    v_exp_f32 v57, v57
    v_mfma_f32_32x32x16_bf16 v[40:55], v[28:31], v[36:39], v[40:55]
    ds_read_b128 v[28:31], v105 offset:16800
    v_exp_f32 v58, v58
    v_exp_f32 v59, v59
    v_exp_f32 v60, v60
    v_exp_f32 v61, v61
    v_exp_f32 v62, v62
    v_mfma_f32_32x32x16_bf16 v[72:87], v[12:15], v[4:7], 0
    ds_read_b128 v[8:11], v2 offset:16384
    v_exp_f32 v63, v63
    v_exp_f32 v64, v64
    v_cvt_pk_bf16_f32 v32, v56, v57
    v_cvt_pk_bf16_f32 v33, v58, v59
    v_cvt_pk_bf16_f32 v34, v60, v61
    v_cvt_pk_bf16_f32 v35, v62, v63
    v_exp_f32 v65, v65
    v_exp_f32 v66, v66
    v_exp_f32 v67, v67
    v_mfma_f32_32x32x16_bf16 v[40:55], v[16:19], v[32:35], v[40:55]
    ds_read_b128 v[20:23], v3 offset:16800
    v_exp_f32 v68, v68
    v_exp_f32 v69, v69
    v_exp_f32 v70, v70
    v_exp_f32 v71, v71
    v_cvt_pk_bf16_f32 v36, v64, v65
    v_cvt_pk_bf16_f32 v37, v66, v67
    v_cvt_pk_bf16_f32 v38, v68, v69
    v_cvt_pk_bf16_f32 v39, v70, v71
    s_waitcnt lgkmcnt(0)
    v_exp_f32 v72, v72
    v_exp_f32 v73, v73
    v_mfma_f32_32x32x16_bf16 v[40:55], v[24:27], v[36:39], v[40:55]
    ds_read_b128 v[24:27], v105 offset:17920
    v_exp_f32 v74, v74
    v_exp_f32 v75, v75
    v_exp_f32 v76, v76
    v_exp_f32 v77, v77
    v_exp_f32 v78, v78
    v_mfma_f32_32x32x16_bf16 v[56:71], v[8:11], v[4:7], 0
    ds_read_b128 v[12:15], v2 offset:17408
    v_exp_f32 v79, v79
    v_exp_f32 v80, v80
    v_cvt_pk_bf16_f32 v32, v72, v73
    v_cvt_pk_bf16_f32 v33, v74, v75
    v_cvt_pk_bf16_f32 v34, v76, v77
    v_cvt_pk_bf16_f32 v35, v78, v79
    v_exp_f32 v81, v81
    v_exp_f32 v82, v82
    v_exp_f32 v83, v83
    v_mfma_f32_32x32x16_bf16 v[40:55], v[20:23], v[32:35], v[40:55]
    ds_read_b128 v[16:19], v3 offset:17920
    v_exp_f32 v84, v84
    v_exp_f32 v85, v85
    v_exp_f32 v86, v86
    v_exp_f32 v87, v87
    v_cvt_pk_bf16_f32 v36, v80, v81
    v_cvt_pk_bf16_f32 v37, v82, v83
    v_cvt_pk_bf16_f32 v38, v84, v85
    v_cvt_pk_bf16_f32 v39, v86, v87
    s_waitcnt lgkmcnt(0)
    v_exp_f32 v56, v56
    v_exp_f32 v57, v57
    v_mfma_f32_32x32x16_bf16 v[40:55], v[28:31], v[36:39], v[40:55]
    ds_read_b128 v[28:31], v105 offset:19040
    v_exp_f32 v58, v58
    v_exp_f32 v59, v59
    v_exp_f32 v60, v60
    v_exp_f32 v61, v61
    v_exp_f32 v62, v62
    v_mfma_f32_32x32x16_bf16 v[72:87], v[12:15], v[4:7], 0
    ds_read_b128 v[8:11], v2 offset:18432
    v_exp_f32 v63, v63
    v_exp_f32 v64, v64
    v_cvt_pk_bf16_f32 v32, v56, v57
    v_cvt_pk_bf16_f32 v33, v58, v59
    v_cvt_pk_bf16_f32 v34, v60, v61
    v_cvt_pk_bf16_f32 v35, v62, v63
    v_exp_f32 v65, v65
    v_exp_f32 v66, v66
    v_exp_f32 v67, v67
    v_mfma_f32_32x32x16_bf16 v[40:55], v[16:19], v[32:35], v[40:55]
    ds_read_b128 v[20:23], v3 offset:19040
    v_exp_f32 v68, v68
    v_exp_f32 v69, v69
    v_exp_f32 v70, v70
    v_exp_f32 v71, v71
    v_cvt_pk_bf16_f32 v36, v64, v65
    v_cvt_pk_bf16_f32 v37, v66, v67
    v_cvt_pk_bf16_f32 v38, v68, v69
    v_cvt_pk_bf16_f32 v39, v70, v71
    s_waitcnt lgkmcnt(0)
    v_exp_f32 v72, v72
    v_exp_f32 v73, v73
    v_mfma_f32_32x32x16_bf16 v[40:55], v[24:27], v[36:39], v[40:55]
    ds_read_b128 v[24:27], v105 offset:20160
    v_exp_f32 v74, v74
    v_exp_f32 v75, v75
    v_exp_f32 v76, v76
    v_exp_f32 v77, v77
    v_exp_f32 v78, v78
    v_mfma_f32_32x32x16_bf16 v[56:71], v[8:11], v[4:7], 0
    ds_read_b128 v[12:15], v2 offset:19456
    v_exp_f32 v79, v79
    v_exp_f32 v80, v80
    v_cvt_pk_bf16_f32 v32, v72, v73
    v_cvt_pk_bf16_f32 v33, v74, v75
    v_cvt_pk_bf16_f32 v34, v76, v77
    v_cvt_pk_bf16_f32 v35, v78, v79
    v_exp_f32 v81, v81
    v_exp_f32 v82, v82
    v_exp_f32 v83, v83
    v_mfma_f32_32x32x16_bf16 v[40:55], v[20:23], v[32:35], v[40:55]
    ds_read_b128 v[16:19], v3 offset:20160
    v_exp_f32 v84, v84
    v_exp_f32 v85, v85
    v_exp_f32 v86, v86
    v_exp_f32 v87, v87
    v_cvt_pk_bf16_f32 v36, v80, v81
    v_cvt_pk_bf16_f32 v37, v82, v83
    v_cvt_pk_bf16_f32 v38, v84, v85
    v_cvt_pk_bf16_f32 v39, v86, v87
    s_waitcnt lgkmcnt(0)
    v_exp_f32 v56, v56
    v_exp_f32 v57, v57
    v_mfma_f32_32x32x16_bf16 v[40:55], v[28:31], v[36:39], v[40:55]
    ds_read_b128 v[28:31], v105 offset:21280
    v_exp_f32 v58, v58
    v_exp_f32 v59, v59
    v_exp_f32 v60, v60
    v_exp_f32 v61, v61
    v_exp_f32 v62, v62
    v_mfma_f32_32x32x16_bf16 v[72:87], v[12:15], v[4:7], 0
    ds_read_b128 v[8:11], v2 offset:20480
    v_exp_f32 v63, v63
    v_exp_f32 v64, v64
    v_cvt_pk_bf16_f32 v32, v56, v57
    v_cvt_pk_bf16_f32 v33, v58, v59
    v_cvt_pk_bf16_f32 v34, v60, v61
    v_cvt_pk_bf16_f32 v35, v62, v63
    v_exp_f32 v65, v65
    v_exp_f32 v66, v66
    v_exp_f32 v67, v67
    v_mfma_f32_32x32x16_bf16 v[40:55], v[16:19], v[32:35], v[40:55]
    ds_read_b128 v[20:23], v3 offset:21280
    v_exp_f32 v68, v68
    v_exp_f32 v69, v69
    v_exp_f32 v70, v70
    v_exp_f32 v71, v71
    v_cvt_pk_bf16_f32 v36, v64, v65
    v_cvt_pk_bf16_f32 v37, v66, v67
    v_cvt_pk_bf16_f32 v38, v68, v69
    v_cvt_pk_bf16_f32 v39, v70, v71
    s_waitcnt lgkmcnt(0)
    v_exp_f32 v72, v72
    v_exp_f32 v73, v73
    v_mfma_f32_32x32x16_bf16 v[40:55], v[24:27], v[36:39], v[40:55]
    ds_read_b128 v[24:27], v105 offset:22400
    v_exp_f32 v74, v74
    v_exp_f32 v75, v75
    v_exp_f32 v76, v76
    v_exp_f32 v77, v77
    v_exp_f32 v78, v78
    v_mfma_f32_32x32x16_bf16 v[56:71], v[8:11], v[4:7], 0
    ds_read_b128 v[12:15], v2 offset:21504
    v_exp_f32 v79, v79
    v_exp_f32 v80, v80
    v_cvt_pk_bf16_f32 v32, v72, v73
    v_cvt_pk_bf16_f32 v33, v74, v75
    v_cvt_pk_bf16_f32 v34, v76, v77
    v_cvt_pk_bf16_f32 v35, v78, v79
    v_exp_f32 v81, v81
    v_exp_f32 v82, v82
    v_exp_f32 v83, v83
    v_mfma_f32_32x32x16_bf16 v[40:55], v[20:23], v[32:35], v[40:55]
    ds_read_b128 v[16:19], v3 offset:22400
    v_exp_f32 v84, v84
    v_exp_f32 v85, v85
    v_exp_f32 v86, v86
    v_exp_f32 v87, v87
    v_cvt_pk_bf16_f32 v36, v80, v81
    v_cvt_pk_bf16_f32 v37, v82, v83
    v_cvt_pk_bf16_f32 v38, v84, v85
    v_cvt_pk_bf16_f32 v39, v86, v87
    s_waitcnt lgkmcnt(0)
    v_exp_f32 v56, v56
    v_exp_f32 v57, v57
    v_mfma_f32_32x32x16_bf16 v[40:55], v[28:31], v[36:39], v[40:55]
    ds_read_b128 v[28:31], v105 offset:23520
    v_exp_f32 v58, v58
    v_exp_f32 v59, v59
    v_exp_f32 v60, v60
    v_exp_f32 v61, v61
    v_exp_f32 v62, v62
    v_mfma_f32_32x32x16_bf16 v[72:87], v[12:15], v[4:7], 0
    ds_read_b128 v[8:11], v2 offset:22528
    v_exp_f32 v63, v63
    v_exp_f32 v64, v64
    v_cvt_pk_bf16_f32 v32, v56, v57
    v_cvt_pk_bf16_f32 v33, v58, v59
    v_cvt_pk_bf16_f32 v34, v60, v61
    v_cvt_pk_bf16_f32 v35, v62, v63
    v_exp_f32 v65, v65
    v_exp_f32 v66, v66
    v_exp_f32 v67, v67
    v_mfma_f32_32x32x16_bf16 v[40:55], v[16:19], v[32:35], v[40:55]
    ds_read_b128 v[20:23], v3 offset:23520
    v_exp_f32 v68, v68
    v_exp_f32 v69, v69
    v_exp_f32 v70, v70
    v_exp_f32 v71, v71
    v_cvt_pk_bf16_f32 v36, v64, v65
    v_cvt_pk_bf16_f32 v37, v66, v67
    v_cvt_pk_bf16_f32 v38, v68, v69
    v_cvt_pk_bf16_f32 v39, v70, v71
    s_waitcnt lgkmcnt(0)
    v_exp_f32 v72, v72
    v_exp_f32 v73, v73
    v_mfma_f32_32x32x16_bf16 v[40:55], v[24:27], v[36:39], v[40:55]
    ds_read_b128 v[24:27], v105 offset:24640
    v_exp_f32 v74, v74
    v_exp_f32 v75, v75
    v_exp_f32 v76, v76
    v_exp_f32 v77, v77
    v_exp_f32 v78, v78
    v_mfma_f32_32x32x16_bf16 v[56:71], v[8:11], v[4:7], 0
    ds_read_b128 v[12:15], v2 offset:23552
    v_exp_f32 v79, v79
    v_exp_f32 v80, v80
    v_cvt_pk_bf16_f32 v32, v72, v73
    v_cvt_pk_bf16_f32 v33, v74, v75
    v_cvt_pk_bf16_f32 v34, v76, v77
    v_cvt_pk_bf16_f32 v35, v78, v79
    v_exp_f32 v81, v81
    v_exp_f32 v82, v82
    v_exp_f32 v83, v83
    v_mfma_f32_32x32x16_bf16 v[40:55], v[20:23], v[32:35], v[40:55]
    ds_read_b128 v[16:19], v3 offset:24640
    v_exp_f32 v84, v84
    v_exp_f32 v85, v85
    v_exp_f32 v86, v86
    v_exp_f32 v87, v87
    v_cvt_pk_bf16_f32 v36, v80, v81
    v_cvt_pk_bf16_f32 v37, v82, v83
    v_cvt_pk_bf16_f32 v38, v84, v85
    v_cvt_pk_bf16_f32 v39, v86, v87
    s_waitcnt lgkmcnt(0)
    v_exp_f32 v56, v56
    v_exp_f32 v57, v57
    v_mfma_f32_32x32x16_bf16 v[40:55], v[28:31], v[36:39], v[40:55]
    ds_read_b128 v[28:31], v105 offset:25760
    v_exp_f32 v58, v58
    v_exp_f32 v59, v59
    v_exp_f32 v60, v60
    v_exp_f32 v61, v61
    v_exp_f32 v62, v62
    v_mfma_f32_32x32x16_bf16 v[72:87], v[12:15], v[4:7], 0
    ds_read_b128 v[8:11], v2 offset:24576
    v_exp_f32 v63, v63
    v_exp_f32 v64, v64
    v_cvt_pk_bf16_f32 v32, v56, v57
    v_cvt_pk_bf16_f32 v33, v58, v59
    v_cvt_pk_bf16_f32 v34, v60, v61
    v_cvt_pk_bf16_f32 v35, v62, v63
    v_exp_f32 v65, v65
    v_exp_f32 v66, v66
    v_exp_f32 v67, v67
    v_mfma_f32_32x32x16_bf16 v[40:55], v[16:19], v[32:35], v[40:55]
    ds_read_b128 v[20:23], v3 offset:25760
    v_exp_f32 v68, v68
    v_exp_f32 v69, v69
    v_exp_f32 v70, v70
    v_exp_f32 v71, v71
    v_cvt_pk_bf16_f32 v36, v64, v65
    v_cvt_pk_bf16_f32 v37, v66, v67
    v_cvt_pk_bf16_f32 v38, v68, v69
    v_cvt_pk_bf16_f32 v39, v70, v71
    s_waitcnt lgkmcnt(0)
    v_exp_f32 v72, v72
    v_exp_f32 v73, v73
    v_mfma_f32_32x32x16_bf16 v[40:55], v[24:27], v[36:39], v[40:55]
    ds_read_b128 v[24:27], v105 offset:26880
    v_exp_f32 v74, v74
    v_exp_f32 v75, v75
    v_exp_f32 v76, v76
    v_exp_f32 v77, v77
    v_exp_f32 v78, v78
    v_mfma_f32_32x32x16_bf16 v[56:71], v[8:11], v[4:7], 0
    ds_read_b128 v[12:15], v2 offset:25600
    v_exp_f32 v79, v79
    v_exp_f32 v80, v80
    v_cvt_pk_bf16_f32 v32, v72, v73
    v_cvt_pk_bf16_f32 v33, v74, v75
    v_cvt_pk_bf16_f32 v34, v76, v77
    v_cvt_pk_bf16_f32 v35, v78, v79
    v_exp_f32 v81, v81
    v_exp_f32 v82, v82
    v_exp_f32 v83, v83
    v_mfma_f32_32x32x16_bf16 v[40:55], v[20:23], v[32:35], v[40:55]
    ds_read_b128 v[16:19], v3 offset:26880
    v_exp_f32 v84, v84
    v_exp_f32 v85, v85
    v_exp_f32 v86, v86
    v_exp_f32 v87, v87
    v_cvt_pk_bf16_f32 v36, v80, v81
    v_cvt_pk_bf16_f32 v37, v82, v83
    v_cvt_pk_bf16_f32 v38, v84, v85
    v_cvt_pk_bf16_f32 v39, v86, v87
    s_waitcnt lgkmcnt(0)
    v_exp_f32 v56, v56
    v_exp_f32 v57, v57
    v_mfma_f32_32x32x16_bf16 v[40:55], v[28:31], v[36:39], v[40:55]
    ds_read_b128 v[28:31], v105 offset:28000
    v_exp_f32 v58, v58
    v_exp_f32 v59, v59
    v_exp_f32 v60, v60
    v_exp_f32 v61, v61
    v_exp_f32 v62, v62
    v_mfma_f32_32x32x16_bf16 v[72:87], v[12:15], v[4:7], 0
    ds_read_b128 v[8:11], v2 offset:26624
    v_exp_f32 v63, v63
    v_exp_f32 v64, v64
    v_cvt_pk_bf16_f32 v32, v56, v57
    v_cvt_pk_bf16_f32 v33, v58, v59
    v_cvt_pk_bf16_f32 v34, v60, v61
    v_cvt_pk_bf16_f32 v35, v62, v63
    v_exp_f32 v65, v65
    v_exp_f32 v66, v66
    v_exp_f32 v67, v67
    v_mfma_f32_32x32x16_bf16 v[40:55], v[16:19], v[32:35], v[40:55]
    ds_read_b128 v[20:23], v3 offset:28000
    v_exp_f32 v68, v68
    v_exp_f32 v69, v69
    v_exp_f32 v70, v70
    v_exp_f32 v71, v71
    v_cvt_pk_bf16_f32 v36, v64, v65
    v_cvt_pk_bf16_f32 v37, v66, v67
    v_cvt_pk_bf16_f32 v38, v68, v69
    v_cvt_pk_bf16_f32 v39, v70, v71
    s_waitcnt lgkmcnt(0)
    v_exp_f32 v72, v72
    v_exp_f32 v73, v73
    v_mfma_f32_32x32x16_bf16 v[40:55], v[24:27], v[36:39], v[40:55]
    ds_read_b128 v[24:27], v105 offset:29120
    v_exp_f32 v74, v74
    v_exp_f32 v75, v75
    v_exp_f32 v76, v76
    v_exp_f32 v77, v77
    v_exp_f32 v78, v78
    v_mfma_f32_32x32x16_bf16 v[56:71], v[8:11], v[4:7], 0
    ds_read_b128 v[12:15], v2 offset:27648
    v_exp_f32 v79, v79
    v_exp_f32 v80, v80
    v_cvt_pk_bf16_f32 v32, v72, v73
    v_cvt_pk_bf16_f32 v33, v74, v75
    v_cvt_pk_bf16_f32 v34, v76, v77
    v_cvt_pk_bf16_f32 v35, v78, v79
    v_exp_f32 v81, v81
    v_exp_f32 v82, v82
    v_exp_f32 v83, v83
    v_mfma_f32_32x32x16_bf16 v[40:55], v[20:23], v[32:35], v[40:55]
    ds_read_b128 v[16:19], v3 offset:29120
    v_exp_f32 v84, v84
    v_exp_f32 v85, v85
    v_exp_f32 v86, v86
    v_exp_f32 v87, v87
    v_cvt_pk_bf16_f32 v36, v80, v81
    v_cvt_pk_bf16_f32 v37, v82, v83
    v_cvt_pk_bf16_f32 v38, v84, v85
    v_cvt_pk_bf16_f32 v39, v86, v87
    s_waitcnt lgkmcnt(0)
    v_exp_f32 v56, v56
    v_exp_f32 v57, v57
    v_mfma_f32_32x32x16_bf16 v[40:55], v[28:31], v[36:39], v[40:55]
    ds_read_b128 v[28:31], v105 offset:30240
    v_exp_f32 v58, v58
    v_exp_f32 v59, v59
    v_exp_f32 v60, v60
    v_exp_f32 v61, v61
    v_exp_f32 v62, v62
    v_mfma_f32_32x32x16_bf16 v[72:87], v[12:15], v[4:7], 0
    ds_read_b128 v[8:11], v2 offset:28672
    v_exp_f32 v63, v63
    v_exp_f32 v64, v64
    v_cvt_pk_bf16_f32 v32, v56, v57
    v_cvt_pk_bf16_f32 v33, v58, v59
    v_cvt_pk_bf16_f32 v34, v60, v61
    v_cvt_pk_bf16_f32 v35, v62, v63
    v_exp_f32 v65, v65
    v_exp_f32 v66, v66
    v_exp_f32 v67, v67
    v_mfma_f32_32x32x16_bf16 v[40:55], v[16:19], v[32:35], v[40:55]
    ds_read_b128 v[20:23], v3 offset:30240
    v_exp_f32 v68, v68
    v_exp_f32 v69, v69
    v_exp_f32 v70, v70
    v_exp_f32 v71, v71
    v_cvt_pk_bf16_f32 v36, v64, v65
    v_cvt_pk_bf16_f32 v37, v66, v67
    v_cvt_pk_bf16_f32 v38, v68, v69
    v_cvt_pk_bf16_f32 v39, v70, v71
    s_waitcnt lgkmcnt(0)
    v_exp_f32 v72, v72
    v_exp_f32 v73, v73
    v_mfma_f32_32x32x16_bf16 v[40:55], v[24:27], v[36:39], v[40:55]
    ds_read_b128 v[24:27], v105 offset:31360
    v_exp_f32 v74, v74
    v_exp_f32 v75, v75
    v_exp_f32 v76, v76
    v_exp_f32 v77, v77
    v_exp_f32 v78, v78
    v_mfma_f32_32x32x16_bf16 v[56:71], v[8:11], v[4:7], 0
    ds_read_b128 v[12:15], v2 offset:29696
    v_exp_f32 v79, v79
    v_exp_f32 v80, v80
    v_cvt_pk_bf16_f32 v32, v72, v73
    v_cvt_pk_bf16_f32 v33, v74, v75
    v_cvt_pk_bf16_f32 v34, v76, v77
    v_cvt_pk_bf16_f32 v35, v78, v79
    v_exp_f32 v81, v81
    v_exp_f32 v82, v82
    v_exp_f32 v83, v83
    v_mfma_f32_32x32x16_bf16 v[40:55], v[20:23], v[32:35], v[40:55]
    ds_read_b128 v[16:19], v3 offset:31360
    v_exp_f32 v84, v84
    v_exp_f32 v85, v85
    v_exp_f32 v86, v86
    v_exp_f32 v87, v87
    v_cvt_pk_bf16_f32 v36, v80, v81
    v_cvt_pk_bf16_f32 v37, v82, v83
    v_cvt_pk_bf16_f32 v38, v84, v85
    v_cvt_pk_bf16_f32 v39, v86, v87
    ds_read_b32 v114, v112 offset:12
    s_waitcnt lgkmcnt(0)
    v_exp_f32 v56, v56
    v_exp_f32 v57, v57
    v_mfma_f32_32x32x16_bf16 v[40:55], v[28:31], v[36:39], v[40:55]
    ds_read_b128 v[28:31], v105 offset:32480
    v_exp_f32 v58, v58
    v_exp_f32 v59, v59
    v_exp_f32 v60, v60
    v_exp_f32 v61, v61
    v_exp_f32 v62, v62
    v_mfma_f32_32x32x16_bf16 v[72:87], v[12:15], v[4:7], 0
    ds_read_b128 v[8:11], v2 offset:30720
    v_exp_f32 v63, v63
    v_exp_f32 v64, v64
    v_cvt_pk_bf16_f32 v32, v56, v57
    v_cvt_pk_bf16_f32 v33, v58, v59
    v_cvt_pk_bf16_f32 v34, v60, v61
    v_cvt_pk_bf16_f32 v35, v62, v63
    v_exp_f32 v65, v65
    v_exp_f32 v66, v66
    v_exp_f32 v67, v67
    v_mfma_f32_32x32x16_bf16 v[40:55], v[16:19], v[32:35], v[40:55]
    ds_read_b128 v[20:23], v3 offset:32480
    v_exp_f32 v68, v68
    v_exp_f32 v69, v69
    v_exp_f32 v70, v70
    v_exp_f32 v71, v71
    v_cvt_pk_bf16_f32 v36, v64, v65
    v_cvt_pk_bf16_f32 v37, v66, v67
    v_cvt_pk_bf16_f32 v38, v68, v69
    v_cvt_pk_bf16_f32 v39, v70, v71
    s_waitcnt lgkmcnt(0)
    v_readfirstlane_b32 s34, v114
    s_nop 0
    s_cmp_lt_u32 s34, 4
    s_cbranch_scc1 at_spin_46
at_back_47:
    s_waitcnt lgkmcnt(0)
    v_exp_f32 v72, v72
    v_exp_f32 v73, v73
    v_mfma_f32_32x32x16_bf16 v[40:55], v[24:27], v[36:39], v[40:55]
    ds_read_b128 v[24:27], v105 offset:33600
    v_exp_f32 v74, v74
    v_exp_f32 v75, v75
    v_exp_f32 v76, v76
    v_exp_f32 v77, v77
    v_exp_f32 v78, v78
    v_mfma_f32_32x32x16_bf16 v[56:71], v[8:11], v[4:7], 0
    ds_read_b128 v[12:15], v2 offset:31744
    v_exp_f32 v79, v79
    v_exp_f32 v80, v80
    v_cvt_pk_bf16_f32 v32, v72, v73
    v_cvt_pk_bf16_f32 v33, v74, v75
    v_cvt_pk_bf16_f32 v34, v76, v77
    v_cvt_pk_bf16_f32 v35, v78, v79
    v_exp_f32 v81, v81
    v_exp_f32 v82, v82
    v_exp_f32 v83, v83
    v_mfma_f32_32x32x16_bf16 v[40:55], v[20:23], v[32:35], v[40:55]
    ds_read_b128 v[16:19], v3 offset:33600
    v_exp_f32 v84, v84
    v_exp_f32 v85, v85
    v_exp_f32 v86, v86
    v_exp_f32 v87, v87
    v_cvt_pk_bf16_f32 v36, v80, v81
    v_cvt_pk_bf16_f32 v37, v82, v83
    v_cvt_pk_bf16_f32 v38, v84, v85
    v_cvt_pk_bf16_f32 v39, v86, v87
    s_waitcnt lgkmcnt(0)
    v_exp_f32 v56, v56
    v_exp_f32 v57, v57
    v_mfma_f32_32x32x16_bf16 v[40:55], v[28:31], v[36:39], v[40:55]
    ds_read_b128 v[28:31], v105 offset:34720
    v_exp_f32 v58, v58
    v_exp_f32 v59, v59
    v_exp_f32 v60, v60
    v_exp_f32 v61, v61
    v_exp_f32 v62, v62
    v_mfma_f32_32x32x16_bf16 v[72:87], v[12:15], v[4:7], 0
    ds_read_b128 v[8:11], v2 offset:32768
    v_exp_f32 v63, v63
    v_exp_f32 v64, v64
    v_cvt_pk_bf16_f32 v32, v56, v57
    v_cvt_pk_bf16_f32 v33, v58, v59
    v_cvt_pk_bf16_f32 v34, v60, v61
    v_cvt_pk_bf16_f32 v35, v62, v63
    v_exp_f32 v65, v65
    v_exp_f32 v66, v66
    v_exp_f32 v67, v67
    v_mfma_f32_32x32x16_bf16 v[40:55], v[16:19], v[32:35], v[40:55]
    ds_read_b128 v[20:23], v3 offset:34720
    v_exp_f32 v68, v68
    v_exp_f32 v69, v69
    v_exp_f32 v70, v70
    v_exp_f32 v71, v71
    v_cvt_pk_bf16_f32 v36, v64, v65
    v_cvt_pk_bf16_f32 v37, v66, v67
    v_cvt_pk_bf16_f32 v38, v68, v69
    v_cvt_pk_bf16_f32 v39, v70, v71
    s_waitcnt lgkmcnt(0)
    v_exp_f32 v72, v72
    v_exp_f32 v73, v73
    v_mfma_f32_32x32x16_bf16 v[40:55], v[24:27], v[36:39], v[40:55]
    ds_read_b128 v[24:27], v105 offset:35840
    v_exp_f32 v74, v74
    v_exp_f32 v75, v75
    v_exp_f32 v76, v76
    v_exp_f32 v77, v77
    v_exp_f32 v78, v78
    v_mfma_f32_32x32x16_bf16 v[56:71], v[8:11], v[4:7], 0
    ds_read_b128 v[12:15], v2 offset:33792
    v_exp_f32 v79, v79
    v_exp_f32 v80, v80
    v_cvt_pk_bf16_f32 v32, v72, v73
    v_cvt_pk_bf16_f32 v33, v74, v75
    v_cvt_pk_bf16_f32 v34, v76, v77
    v_cvt_pk_bf16_f32 v35, v78, v79
    v_exp_f32 v81, v81
    v_exp_f32 v82, v82
    v_exp_f32 v83, v83
    v_mfma_f32_32x32x16_bf16 v[40:55], v[20:23], v[32:35], v[40:55]
    ds_read_b128 v[16:19], v3 offset:35840
    v_exp_f32 v84, v84
    v_exp_f32 v85, v85
    v_exp_f32 v86, v86
    v_exp_f32 v87, v87
    v_cvt_pk_bf16_f32 v36, v80, v81
    v_cvt_pk_bf16_f32 v37, v82, v83
    v_cvt_pk_bf16_f32 v38, v84, v85
    v_cvt_pk_bf16_f32 v39, v86, v87
    v_add_u32 v3, 35840, v3
    v_add_u32 v105, 35840, v105
    s_waitcnt lgkmcnt(0)
    v_exp_f32 v56, v56
    v_exp_f32 v57, v57
    v_mfma_f32_32x32x16_bf16 v[40:55], v[28:31], v[36:39], v[40:55]
    ds_read_b128 v[28:31], v105 offset:1120
    v_exp_f32 v58, v58
    v_exp_f32 v59, v59
    v_exp_f32 v60, v60
    v_exp_f32 v61, v61
    v_exp_f32 v62, v62
    v_mfma_f32_32x32x16_bf16 v[72:87], v[12:15], v[4:7], 0
    ds_read_b128 v[8:11], v2 offset:34816
    v_exp_f32 v63, v63
    v_exp_f32 v64, v64
    v_cvt_pk_bf16_f32 v32, v56, v57
    v_cvt_pk_bf16_f32 v33, v58, v59
    v_cvt_pk_bf16_f32 v34, v60, v61
    v_cvt_pk_bf16_f32 v35, v62, v63
    v_exp_f32 v65, v65
    v_exp_f32 v66, v66
    v_exp_f32 v67, v67
    v_mfma_f32_32x32x16_bf16 v[40:55], v[16:19], v[32:35], v[40:55]
    ds_read_b128 v[20:23], v3 offset:1120
    v_exp_f32 v68, v68
    v_exp_f32 v69, v69
    v_exp_f32 v70, v70
    v_exp_f32 v71, v71
    v_cvt_pk_bf16_f32 v36, v64, v65
    v_cvt_pk_bf16_f32 v37, v66, v67
    v_cvt_pk_bf16_f32 v38, v68, v69
    v_cvt_pk_bf16_f32 v39, v70, v71
    s_waitcnt lgkmcnt(0)
    v_exp_f32 v72, v72
    v_exp_f32 v73, v73
    v_mfma_f32_32x32x16_bf16 v[40:55], v[24:27], v[36:39], v[40:55]
    ds_read_b128 v[24:27], v105 offset:2240
    v_exp_f32 v74, v74
    v_exp_f32 v75, v75
    v_exp_f32 v76, v76
    v_exp_f32 v77, v77
    v_exp_f32 v78, v78
    v_mfma_f32_32x32x16_bf16 v[56:71], v[8:11], v[4:7], 0
    ds_read_b128 v[12:15], v2 offset:35840
    v_exp_f32 v79, v79
    v_exp_f32 v80, v80
    v_cvt_pk_bf16_f32 v32, v72, v73
    v_cvt_pk_bf16_f32 v33, v74, v75
    v_cvt_pk_bf16_f32 v34, v76, v77
    v_cvt_pk_bf16_f32 v35, v78, v79
    v_exp_f32 v81, v81
    v_exp_f32 v82, v82
    v_exp_f32 v83, v83
    v_mfma_f32_32x32x16_bf16 v[40:55], v[20:23], v[32:35], v[40:55]
    ds_read_b128 v[16:19], v3 offset:2240
    v_exp_f32 v84, v84
    v_exp_f32 v85, v85
    v_exp_f32 v86, v86
    v_exp_f32 v87, v87
    v_cvt_pk_bf16_f32 v36, v80, v81
    v_cvt_pk_bf16_f32 v37, v82, v83
    v_cvt_pk_bf16_f32 v38, v84, v85
    v_cvt_pk_bf16_f32 v39, v86, v87
    s_waitcnt lgkmcnt(0)
    v_exp_f32 v56, v56
    v_exp_f32 v57, v57
    v_mfma_f32_32x32x16_bf16 v[40:55], v[28:31], v[36:39], v[40:55]
    ds_read_b128 v[28:31], v105 offset:3360
    v_exp_f32 v58, v58
    v_exp_f32 v59, v59
    v_exp_f32 v60, v60
    v_exp_f32 v61, v61
    v_exp_f32 v62, v62
    v_mfma_f32_32x32x16_bf16 v[72:87], v[12:15], v[4:7], 0
    ds_read_b128 v[8:11], v2 offset:36864
    v_exp_f32 v63, v63
    v_exp_f32 v64, v64
    v_cvt_pk_bf16_f32 v32, v56, v57
    v_cvt_pk_bf16_f32 v33, v58, v59
    v_cvt_pk_bf16_f32 v34, v60, v61
    v_cvt_pk_bf16_f32 v35, v62, v63
    v_exp_f32 v65, v65
    v_exp_f32 v66, v66
    v_exp_f32 v67, v67
    v_mfma_f32_32x32x16_bf16 v[40:55], v[16:19], v[32:35], v[40:55]
    ds_read_b128 v[20:23], v3 offset:3360
    v_exp_f32 v68, v68
    v_exp_f32 v69, v69
    v_exp_f32 v70, v70
    v_exp_f32 v71, v71
    v_cvt_pk_bf16_f32 v36, v64, v65
    v_cvt_pk_bf16_f32 v37, v66, v67
    v_cvt_pk_bf16_f32 v38, v68, v69
    v_cvt_pk_bf16_f32 v39, v70, v71
    s_waitcnt lgkmcnt(0)
    v_exp_f32 v72, v72
    v_exp_f32 v73, v73
    v_mfma_f32_32x32x16_bf16 v[40:55], v[24:27], v[36:39], v[40:55]
    ds_read_b128 v[24:27], v105 offset:4480
    v_exp_f32 v74, v74
    v_exp_f32 v75, v75
    v_exp_f32 v76, v76
    v_exp_f32 v77, v77
    v_exp_f32 v78, v78
    v_mfma_f32_32x32x16_bf16 v[56:71], v[8:11], v[4:7], 0
    ds_read_b128 v[12:15], v2 offset:37888
    v_exp_f32 v79, v79
    v_exp_f32 v80, v80
    v_cvt_pk_bf16_f32 v32, v72, v73
    v_cvt_pk_bf16_f32 v33, v74, v75
    v_cvt_pk_bf16_f32 v34, v76, v77
    v_cvt_pk_bf16_f32 v35, v78, v79
    v_exp_f32 v81, v81
    v_exp_f32 v82, v82
    v_exp_f32 v83, v83
    v_mfma_f32_32x32x16_bf16 v[40:55], v[20:23], v[32:35], v[40:55]
    ds_read_b128 v[16:19], v3 offset:4480
    v_exp_f32 v84, v84
    v_exp_f32 v85, v85
    v_exp_f32 v86, v86
    v_exp_f32 v87, v87
    v_cvt_pk_bf16_f32 v36, v80, v81
    v_cvt_pk_bf16_f32 v37, v82, v83
    v_cvt_pk_bf16_f32 v38, v84, v85
    v_cvt_pk_bf16_f32 v39, v86, v87
    s_waitcnt lgkmcnt(0)
    v_exp_f32 v56, v56
    v_exp_f32 v57, v57
    v_mfma_f32_32x32x16_bf16 v[40:55], v[28:31], v[36:39], v[40:55]
    ds_read_b128 v[28:31], v105 offset:5600
    v_exp_f32 v58, v58
    v_exp_f32 v59, v59
    v_exp_f32 v60, v60
    v_exp_f32 v61, v61
    v_exp_f32 v62, v62
    v_mfma_f32_32x32x16_bf16 v[72:87], v[12:15], v[4:7], 0
    ds_read_b128 v[8:11], v2 offset:38912
    v_exp_f32 v63, v63
    v_exp_f32 v64, v64
    v_cvt_pk_bf16_f32 v32, v56, v57
    v_cvt_pk_bf16_f32 v33, v58, v59
    v_cvt_pk_bf16_f32 v34, v60, v61
    v_cvt_pk_bf16_f32 v35, v62, v63
    v_exp_f32 v65, v65
    v_exp_f32 v66, v66
    v_exp_f32 v67, v67
    v_mfma_f32_32x32x16_bf16 v[40:55], v[16:19], v[32:35], v[40:55]
    ds_read_b128 v[20:23], v3 offset:5600
    v_exp_f32 v68, v68
    v_exp_f32 v69, v69
    v_exp_f32 v70, v70
    v_exp_f32 v71, v71
    v_cvt_pk_bf16_f32 v36, v64, v65
    v_cvt_pk_bf16_f32 v37, v66, v67
    v_cvt_pk_bf16_f32 v38, v68, v69
    v_cvt_pk_bf16_f32 v39, v70, v71
    s_waitcnt lgkmcnt(0)
    v_exp_f32 v72, v72
    v_exp_f32 v73, v73
    v_mfma_f32_32x32x16_bf16 v[40:55], v[24:27], v[36:39], v[40:55]
    ds_read_b128 v[24:27], v105 offset:6720
    v_exp_f32 v74, v74
    v_exp_f32 v75, v75
    v_exp_f32 v76, v76
    v_exp_f32 v77, v77
    v_exp_f32 v78, v78
    v_mfma_f32_32x32x16_bf16 v[56:71], v[8:11], v[4:7], 0
    ds_read_b128 v[12:15], v2 offset:39936
    v_exp_f32 v79, v79
    v_exp_f32 v80, v80
    v_cvt_pk_bf16_f32 v32, v72, v73
    v_cvt_pk_bf16_f32 v33, v74, v75
    v_cvt_pk_bf16_f32 v34, v76, v77
    v_cvt_pk_bf16_f32 v35, v78, v79
    v_exp_f32 v81, v81
    v_exp_f32 v82, v82
    v_exp_f32 v83, v83
    v_mfma_f32_32x32x16_bf16 v[40:55], v[20:23], v[32:35], v[40:55]
    ds_read_b128 v[16:19], v3 offset:6720
    v_exp_f32 v84, v84
    v_exp_f32 v85, v85
    v_exp_f32 v86, v86
    v_exp_f32 v87, v87
    v_cvt_pk_bf16_f32 v36, v80, v81
    v_cvt_pk_bf16_f32 v37, v82, v83
    v_cvt_pk_bf16_f32 v38, v84, v85
    v_cvt_pk_bf16_f32 v39, v86, v87
    s_waitcnt lgkmcnt(0)
    v_exp_f32 v56, v56
    v_exp_f32 v57, v57
    v_mfma_f32_32x32x16_bf16 v[40:55], v[28:31], v[36:39], v[40:55]
    ds_read_b128 v[28:31], v105 offset:7840
    v_exp_f32 v58, v58
    v_exp_f32 v59, v59
    v_exp_f32 v60, v60
    v_exp_f32 v61, v61
    v_exp_f32 v62, v62
    v_mfma_f32_32x32x16_bf16 v[72:87], v[12:15], v[4:7], 0
    ds_read_b128 v[8:11], v2 offset:40960
    v_exp_f32 v63, v63
    v_exp_f32 v64, v64
    v_cvt_pk_bf16_f32 v32, v56, v57
    v_cvt_pk_bf16_f32 v33, v58, v59
    v_cvt_pk_bf16_f32 v34, v60, v61
    v_cvt_pk_bf16_f32 v35, v62, v63
    v_exp_f32 v65, v65
    v_exp_f32 v66, v66
    v_exp_f32 v67, v67
    v_mfma_f32_32x32x16_bf16 v[40:55], v[16:19], v[32:35], v[40:55]
    ds_read_b128 v[20:23], v3 offset:7840
    v_exp_f32 v68, v68
    v_exp_f32 v69, v69
    v_exp_f32 v70, v70
    v_exp_f32 v71, v71
    v_cvt_pk_bf16_f32 v36, v64, v65
    v_cvt_pk_bf16_f32 v37, v66, v67
    v_cvt_pk_bf16_f32 v38, v68, v69
    v_cvt_pk_bf16_f32 v39, v70, v71
    s_waitcnt lgkmcnt(0)
    v_exp_f32 v72, v72
    v_exp_f32 v73, v73
    v_mfma_f32_32x32x16_bf16 v[40:55], v[24:27], v[36:39], v[40:55]
    ds_read_b128 v[24:27], v105 offset:8960
    v_exp_f32 v74, v74
    v_exp_f32 v75, v75
    v_exp_f32 v76, v76
    v_exp_f32 v77, v77
    v_exp_f32 v78, v78
    v_mfma_f32_32x32x16_bf16 v[56:71], v[8:11], v[4:7], 0
    ds_read_b128 v[12:15], v2 offset:41984
    v_exp_f32 v79, v79
    v_exp_f32 v80, v80
    v_cvt_pk_bf16_f32 v32, v72, v73
    v_cvt_pk_bf16_f32 v33, v74, v75
    v_cvt_pk_bf16_f32 v34, v76, v77
    v_cvt_pk_bf16_f32 v35, v78, v79
    v_exp_f32 v81, v81
    v_exp_f32 v82, v82
    v_exp_f32 v83, v83
    v_mfma_f32_32x32x16_bf16 v[40:55], v[20:23], v[32:35], v[40:55]
    ds_read_b128 v[16:19], v3 offset:8960
    v_exp_f32 v84, v84
    v_exp_f32 v85, v85
    v_exp_f32 v86, v86
    v_exp_f32 v87, v87
    v_cvt_pk_bf16_f32 v36, v80, v81
    v_cvt_pk_bf16_f32 v37, v82, v83
    v_cvt_pk_bf16_f32 v38, v84, v85
    v_cvt_pk_bf16_f32 v39, v86, v87
    s_waitcnt lgkmcnt(0)
    v_exp_f32 v56, v56
    v_exp_f32 v57, v57
    v_mfma_f32_32x32x16_bf16 v[40:55], v[28:31], v[36:39], v[40:55]
    ds_read_b128 v[28:31], v105 offset:10080
    v_exp_f32 v58, v58
    v_exp_f32 v59, v59
    v_exp_f32 v60, v60
    v_exp_f32 v61, v61
    v_exp_f32 v62, v62
    v_mfma_f32_32x32x16_bf16 v[72:87], v[12:15], v[4:7], 0
    ds_read_b128 v[8:11], v2 offset:43008
    v_exp_f32 v63, v63
    v_exp_f32 v64, v64
    v_cvt_pk_bf16_f32 v32, v56, v57
    v_cvt_pk_bf16_f32 v33, v58, v59
    v_cvt_pk_bf16_f32 v34, v60, v61
    v_cvt_pk_bf16_f32 v35, v62, v63
    v_exp_f32 v65, v65
    v_exp_f32 v66, v66
    v_exp_f32 v67, v67
    v_mfma_f32_32x32x16_bf16 v[40:55], v[16:19], v[32:35], v[40:55]
    ds_read_b128 v[20:23], v3 offset:10080
    v_exp_f32 v68, v68
    v_exp_f32 v69, v69
    v_exp_f32 v70, v70
    v_exp_f32 v71, v71
    v_cvt_pk_bf16_f32 v36, v64, v65
    v_cvt_pk_bf16_f32 v37, v66, v67
    v_cvt_pk_bf16_f32 v38, v68, v69
    v_cvt_pk_bf16_f32 v39, v70, v71
    s_waitcnt lgkmcnt(0)
    v_exp_f32 v72, v72
    v_exp_f32 v73, v73
    v_mfma_f32_32x32x16_bf16 v[40:55], v[24:27], v[36:39], v[40:55]
    ds_read_b128 v[24:27], v105 offset:11200
    v_exp_f32 v74, v74
    v_exp_f32 v75, v75
    v_exp_f32 v76, v76
    v_exp_f32 v77, v77
    v_exp_f32 v78, v78
    v_mfma_f32_32x32x16_bf16 v[56:71], v[8:11], v[4:7], 0
    ds_read_b128 v[12:15], v2 offset:44032
    v_exp_f32 v79, v79
    v_exp_f32 v80, v80
    v_cvt_pk_bf16_f32 v32, v72, v73
    v_cvt_pk_bf16_f32 v33, v74, v75
    v_cvt_pk_bf16_f32 v34, v76, v77
    v_cvt_pk_bf16_f32 v35, v78, v79
    v_exp_f32 v81, v81
    v_exp_f32 v82, v82
    v_exp_f32 v83, v83
    v_mfma_f32_32x32x16_bf16 v[40:55], v[20:23], v[32:35], v[40:55]
    ds_read_b128 v[16:19], v3 offset:11200
    v_exp_f32 v84, v84
    v_exp_f32 v85, v85
    v_exp_f32 v86, v86
    v_exp_f32 v87, v87
    v_cvt_pk_bf16_f32 v36, v80, v81
    v_cvt_pk_bf16_f32 v37, v82, v83
    v_cvt_pk_bf16_f32 v38, v84, v85
    v_cvt_pk_bf16_f32 v39, v86, v87
    s_waitcnt lgkmcnt(0)
    v_exp_f32 v56, v56
    v_exp_f32 v57, v57
    v_mfma_f32_32x32x16_bf16 v[40:55], v[28:31], v[36:39], v[40:55]
    ds_read_b128 v[28:31], v105 offset:12320
    v_exp_f32 v58, v58
    v_exp_f32 v59, v59
    v_exp_f32 v60, v60
    v_exp_f32 v61, v61
    v_exp_f32 v62, v62
    v_mfma_f32_32x32x16_bf16 v[72:87], v[12:15], v[4:7], 0
    ds_read_b128 v[8:11], v2 offset:45056
    v_exp_f32 v63, v63
    v_exp_f32 v64, v64
    v_cvt_pk_bf16_f32 v32, v56, v57
    v_cvt_pk_bf16_f32 v33, v58, v59
    v_cvt_pk_bf16_f32 v34, v60, v61
    v_cvt_pk_bf16_f32 v35, v62, v63
    v_exp_f32 v65, v65
    v_exp_f32 v66, v66
    v_exp_f32 v67, v67
    v_mfma_f32_32x32x16_bf16 v[40:55], v[16:19], v[32:35], v[40:55]
    ds_read_b128 v[20:23], v3 offset:12320
    v_exp_f32 v68, v68
    v_exp_f32 v69, v69
    v_exp_f32 v70, v70
    v_exp_f32 v71, v71
    v_cvt_pk_bf16_f32 v36, v64, v65
    v_cvt_pk_bf16_f32 v37, v66, v67
    v_cvt_pk_bf16_f32 v38, v68, v69
    v_cvt_pk_bf16_f32 v39, v70, v71
    s_waitcnt lgkmcnt(0)
    v_exp_f32 v72, v72
    v_exp_f32 v73, v73
    v_mfma_f32_32x32x16_bf16 v[40:55], v[24:27], v[36:39], v[40:55]
    ds_read_b128 v[24:27], v105 offset:13440
    v_exp_f32 v74, v74
    v_exp_f32 v75, v75
    v_exp_f32 v76, v76
    v_exp_f32 v77, v77
    v_exp_f32 v78, v78
    v_mfma_f32_32x32x16_bf16 v[56:71], v[8:11], v[4:7], 0
    ds_read_b128 v[12:15], v2 offset:46080
    v_exp_f32 v79, v79
    v_exp_f32 v80, v80
    v_cvt_pk_bf16_f32 v32, v72, v73
    v_cvt_pk_bf16_f32 v33, v74, v75
    v_cvt_pk_bf16_f32 v34, v76, v77
    v_cvt_pk_bf16_f32 v35, v78, v79
    v_exp_f32 v81, v81
    v_exp_f32 v82, v82
    v_exp_f32 v83, v83
    v_mfma_f32_32x32x16_bf16 v[40:55], v[20:23], v[32:35], v[40:55]
    ds_read_b128 v[16:19], v3 offset:13440
    v_exp_f32 v84, v84
    v_exp_f32 v85, v85
    v_exp_f32 v86, v86
    v_exp_f32 v87, v87
    v_cvt_pk_bf16_f32 v36, v80, v81
    v_cvt_pk_bf16_f32 v37, v82, v83
    v_cvt_pk_bf16_f32 v38, v84, v85
    v_cvt_pk_bf16_f32 v39, v86, v87
    s_waitcnt lgkmcnt(0)
    v_exp_f32 v56, v56
    v_exp_f32 v57, v57
    v_mfma_f32_32x32x16_bf16 v[40:55], v[28:31], v[36:39], v[40:55]
    ds_read_b128 v[28:31], v105 offset:14560
    v_exp_f32 v58, v58
    v_exp_f32 v59, v59
    v_exp_f32 v60, v60
    v_exp_f32 v61, v61
    v_exp_f32 v62, v62
    v_mfma_f32_32x32x16_bf16 v[72:87], v[12:15], v[4:7], 0
    ds_read_b128 v[8:11], v2 offset:47104
    v_exp_f32 v63, v63
    v_exp_f32 v64, v64
    v_cvt_pk_bf16_f32 v32, v56, v57
    v_cvt_pk_bf16_f32 v33, v58, v59
    v_cvt_pk_bf16_f32 v34, v60, v61
    v_cvt_pk_bf16_f32 v35, v62, v63
    v_exp_f32 v65, v65
    v_exp_f32 v66, v66
    v_exp_f32 v67, v67
    v_mfma_f32_32x32x16_bf16 v[40:55], v[16:19], v[32:35], v[40:55]
    ds_read_b128 v[20:23], v3 offset:14560
    v_exp_f32 v68, v68
    v_exp_f32 v69, v69
    v_exp_f32 v70, v70
    v_exp_f32 v71, v71
    v_cvt_pk_bf16_f32 v36, v64, v65
    v_cvt_pk_bf16_f32 v37, v66, v67
    v_cvt_pk_bf16_f32 v38, v68, v69
    v_cvt_pk_bf16_f32 v39, v70, v71
    s_waitcnt lgkmcnt(0)
    v_exp_f32 v72, v72
    v_exp_f32 v73, v73
    v_mfma_f32_32x32x16_bf16 v[40:55], v[24:27], v[36:39], v[40:55]
    ds_read_b128 v[24:27], v105 offset:15680
    v_exp_f32 v74, v74
    v_exp_f32 v75, v75
    v_exp_f32 v76, v76
    v_exp_f32 v77, v77
    v_exp_f32 v78, v78
    v_mfma_f32_32x32x16_bf16 v[56:71], v[8:11], v[4:7], 0
    ds_read_b128 v[12:15], v2 offset:48128
    v_exp_f32 v79, v79
    v_exp_f32 v80, v80
    v_cvt_pk_bf16_f32 v32, v72, v73
    v_cvt_pk_bf16_f32 v33, v74, v75
    v_cvt_pk_bf16_f32 v34, v76, v77
    v_cvt_pk_bf16_f32 v35, v78, v79
    v_exp_f32 v81, v81
    v_exp_f32 v82, v82
    v_exp_f32 v83, v83
    v_mfma_f32_32x32x16_bf16 v[40:55], v[20:23], v[32:35], v[40:55]
    ds_read_b128 v[16:19], v3 offset:15680
    v_exp_f32 v84, v84
    v_exp_f32 v85, v85
    v_exp_f32 v86, v86
    v_exp_f32 v87, v87
    v_cvt_pk_bf16_f32 v36, v80, v81
    v_cvt_pk_bf16_f32 v37, v82, v83
    v_cvt_pk_bf16_f32 v38, v84, v85
    v_cvt_pk_bf16_f32 v39, v86, v87
    s_waitcnt lgkmcnt(0)
    v_exp_f32 v56, v56
    v_exp_f32 v57, v57
    v_mfma_f32_32x32x16_bf16 v[40:55], v[28:31], v[36:39], v[40:55]
    ds_read_b128 v[28:31], v105 offset:16800
    v_exp_f32 v58, v58
    v_exp_f32 v59, v59
    v_exp_f32 v60, v60
    v_exp_f32 v61, v61
    v_exp_f32 v62, v62
    v_mfma_f32_32x32x16_bf16 v[72:87], v[12:15], v[4:7], 0
    ds_read_b128 v[8:11], v2 offset:49152
    v_exp_f32 v63, v63
    v_exp_f32 v64, v64
    v_cvt_pk_bf16_f32 v32, v56, v57
    v_cvt_pk_bf16_f32 v33, v58, v59
    v_cvt_pk_bf16_f32 v34, v60, v61
    v_cvt_pk_bf16_f32 v35, v62, v63
    v_exp_f32 v65, v65
    v_exp_f32 v66, v66
    v_exp_f32 v67, v67
    v_mfma_f32_32x32x16_bf16 v[40:55], v[16:19], v[32:35], v[40:55]
    ds_read_b128 v[20:23], v3 offset:16800
    v_exp_f32 v68, v68
    v_exp_f32 v69, v69
    v_exp_f32 v70, v70
    v_exp_f32 v71, v71
    v_cvt_pk_bf16_f32 v36, v64, v65
    v_cvt_pk_bf16_f32 v37, v66, v67
    v_cvt_pk_bf16_f32 v38, v68, v69
    v_cvt_pk_bf16_f32 v39, v70, v71
    s_waitcnt lgkmcnt(0)
    v_exp_f32 v72, v72
    v_exp_f32 v73, v73
    v_mfma_f32_32x32x16_bf16 v[40:55], v[24:27], v[36:39], v[40:55]
    ds_read_b128 v[24:27], v105 offset:17920
    v_exp_f32 v74, v74
    v_exp_f32 v75, v75
    v_exp_f32 v76, v76
    v_exp_f32 v77, v77
    v_exp_f32 v78, v78
    v_mfma_f32_32x32x16_bf16 v[56:71], v[8:11], v[4:7], 0
    ds_read_b128 v[12:15], v2 offset:50176
    v_exp_f32 v79, v79
    v_exp_f32 v80, v80
    v_cvt_pk_bf16_f32 v32, v72, v73
    v_cvt_pk_bf16_f32 v33, v74, v75
    v_cvt_pk_bf16_f32 v34, v76, v77
    v_cvt_pk_bf16_f32 v35, v78, v79
    v_exp_f32 v81, v81
    v_exp_f32 v82, v82
    v_exp_f32 v83, v83
    v_mfma_f32_32x32x16_bf16 v[40:55], v[20:23], v[32:35], v[40:55]
    ds_read_b128 v[16:19], v3 offset:17920
    v_exp_f32 v84, v84
    v_exp_f32 v85, v85
    v_exp_f32 v86, v86
    v_exp_f32 v87, v87
    v_cvt_pk_bf16_f32 v36, v80, v81
    v_cvt_pk_bf16_f32 v37, v82, v83
    v_cvt_pk_bf16_f32 v38, v84, v85
    v_cvt_pk_bf16_f32 v39, v86, v87
    s_waitcnt lgkmcnt(0)
    v_exp_f32 v56, v56
    v_exp_f32 v57, v57
    v_mfma_f32_32x32x16_bf16 v[40:55], v[28:31], v[36:39], v[40:55]
    ds_read_b128 v[28:31], v105 offset:19040
    v_exp_f32 v58, v58
    v_exp_f32 v59, v59
    v_exp_f32 v60, v60
    v_exp_f32 v61, v61
    v_exp_f32 v62, v62
    v_mfma_f32_32x32x16_bf16 v[72:87], v[12:15], v[4:7], 0
    ds_read_b128 v[8:11], v2 offset:51200
    v_exp_f32 v63, v63
    v_exp_f32 v64, v64
    v_cvt_pk_bf16_f32 v32, v56, v57
    v_cvt_pk_bf16_f32 v33, v58, v59
    v_cvt_pk_bf16_f32 v34, v60, v61
    v_cvt_pk_bf16_f32 v35, v62, v63
    v_exp_f32 v65, v65
    v_exp_f32 v66, v66
    v_exp_f32 v67, v67
    v_mfma_f32_32x32x16_bf16 v[40:55], v[16:19], v[32:35], v[40:55]
    ds_read_b128 v[20:23], v3 offset:19040
    v_exp_f32 v68, v68
    v_exp_f32 v69, v69
    v_exp_f32 v70, v70
    v_exp_f32 v71, v71
    v_cvt_pk_bf16_f32 v36, v64, v65
    v_cvt_pk_bf16_f32 v37, v66, v67
    v_cvt_pk_bf16_f32 v38, v68, v69
    v_cvt_pk_bf16_f32 v39, v70, v71
    s_waitcnt lgkmcnt(0)
    v_exp_f32 v72, v72
    v_exp_f32 v73, v73
    v_mfma_f32_32x32x16_bf16 v[40:55], v[24:27], v[36:39], v[40:55]
    ds_read_b128 v[24:27], v105 offset:20160
    v_exp_f32 v74, v74
    v_exp_f32 v75, v75
    v_exp_f32 v76, v76
    v_exp_f32 v77, v77
    v_exp_f32 v78, v78
    v_mfma_f32_32x32x16_bf16 v[56:71], v[8:11], v[4:7], 0
    ds_read_b128 v[12:15], v2 offset:52224
    v_exp_f32 v79, v79
    v_exp_f32 v80, v80
    v_cvt_pk_bf16_f32 v32, v72, v73
    v_cvt_pk_bf16_f32 v33, v74, v75
    v_cvt_pk_bf16_f32 v34, v76, v77
    v_cvt_pk_bf16_f32 v35, v78, v79
    v_exp_f32 v81, v81
    v_exp_f32 v82, v82
    v_exp_f32 v83, v83
    v_mfma_f32_32x32x16_bf16 v[40:55], v[20:23], v[32:35], v[40:55]
    ds_read_b128 v[16:19], v3 offset:20160
    v_exp_f32 v84, v84
    v_exp_f32 v85, v85
    v_exp_f32 v86, v86
    v_exp_f32 v87, v87
    v_cvt_pk_bf16_f32 v36, v80, v81
    v_cvt_pk_bf16_f32 v37, v82, v83
    v_cvt_pk_bf16_f32 v38, v84, v85
    v_cvt_pk_bf16_f32 v39, v86, v87
    s_waitcnt lgkmcnt(0)
    v_exp_f32 v56, v56
    v_exp_f32 v57, v57
    v_mfma_f32_32x32x16_bf16 v[40:55], v[28:31], v[36:39], v[40:55]
    ds_read_b128 v[28:31], v105 offset:21280
    v_exp_f32 v58, v58
    v_exp_f32 v59, v59
    v_exp_f32 v60, v60
    v_exp_f32 v61, v61
    v_exp_f32 v62, v62
    v_mfma_f32_32x32x16_bf16 v[72:87], v[12:15], v[4:7], 0
    ds_read_b128 v[8:11], v2 offset:53248
    v_exp_f32 v63, v63
    v_exp_f32 v64, v64
    v_cvt_pk_bf16_f32 v32, v56, v57
    v_cvt_pk_bf16_f32 v33, v58, v59
    v_cvt_pk_bf16_f32 v34, v60, v61
    v_cvt_pk_bf16_f32 v35, v62, v63
    v_exp_f32 v65, v65
    v_exp_f32 v66, v66
    v_exp_f32 v67, v67
    v_mfma_f32_32x32x16_bf16 v[40:55], v[16:19], v[32:35], v[40:55]
    ds_read_b128 v[20:23], v3 offset:21280
    v_exp_f32 v68, v68
    v_exp_f32 v69, v69
    v_exp_f32 v70, v70
    v_exp_f32 v71, v71
    v_cvt_pk_bf16_f32 v36, v64, v65
    v_cvt_pk_bf16_f32 v37, v66, v67
    v_cvt_pk_bf16_f32 v38, v68, v69
    v_cvt_pk_bf16_f32 v39, v70, v71
    s_waitcnt lgkmcnt(0)
    v_exp_f32 v72, v72
    v_exp_f32 v73, v73
    v_mfma_f32_32x32x16_bf16 v[40:55], v[24:27], v[36:39], v[40:55]
    ds_read_b128 v[24:27], v105 offset:22400
    v_exp_f32 v74, v74
    v_exp_f32 v75, v75
    v_exp_f32 v76, v76
    v_exp_f32 v77, v77
    v_exp_f32 v78, v78
    v_mfma_f32_32x32x16_bf16 v[56:71], v[8:11], v[4:7], 0
    ds_read_b128 v[12:15], v2 offset:54272
    v_exp_f32 v79, v79
    v_exp_f32 v80, v80
    v_cvt_pk_bf16_f32 v32, v72, v73
    v_cvt_pk_bf16_f32 v33, v74, v75
    v_cvt_pk_bf16_f32 v34, v76, v77
    v_cvt_pk_bf16_f32 v35, v78, v79
    v_exp_f32 v81, v81
    v_exp_f32 v82, v82
    v_exp_f32 v83, v83
    v_mfma_f32_32x32x16_bf16 v[40:55], v[20:23], v[32:35], v[40:55]
    ds_read_b128 v[16:19], v3 offset:22400
    v_exp_f32 v84, v84
    v_exp_f32 v85, v85
    v_exp_f32 v86, v86
    v_exp_f32 v87, v87
    v_cvt_pk_bf16_f32 v36, v80, v81
    v_cvt_pk_bf16_f32 v37, v82, v83
    v_cvt_pk_bf16_f32 v38, v84, v85
    v_cvt_pk_bf16_f32 v39, v86, v87
    s_waitcnt lgkmcnt(0)
    v_exp_f32 v56, v56
    v_exp_f32 v57, v57
    v_mfma_f32_32x32x16_bf16 v[40:55], v[28:31], v[36:39], v[40:55]
    ds_read_b128 v[28:31], v105 offset:23520
    v_exp_f32 v58, v58
    v_exp_f32 v59, v59
    v_exp_f32 v60, v60
    v_exp_f32 v61, v61
    v_exp_f32 v62, v62
    v_mfma_f32_32x32x16_bf16 v[72:87], v[12:15], v[4:7], 0
    ds_read_b128 v[8:11], v2 offset:55296
    v_exp_f32 v63, v63
    v_exp_f32 v64, v64
    v_cvt_pk_bf16_f32 v32, v56, v57
    v_cvt_pk_bf16_f32 v33, v58, v59
    v_cvt_pk_bf16_f32 v34, v60, v61
    v_cvt_pk_bf16_f32 v35, v62, v63
    v_exp_f32 v65, v65
    v_exp_f32 v66, v66
    v_exp_f32 v67, v67
    v_mfma_f32_32x32x16_bf16 v[40:55], v[16:19], v[32:35], v[40:55]
    ds_read_b128 v[20:23], v3 offset:23520
    v_exp_f32 v68, v68
    v_exp_f32 v69, v69
    v_exp_f32 v70, v70
    v_exp_f32 v71, v71
    v_cvt_pk_bf16_f32 v36, v64, v65
    v_cvt_pk_bf16_f32 v37, v66, v67
    v_cvt_pk_bf16_f32 v38, v68, v69
    v_cvt_pk_bf16_f32 v39, v70, v71
    s_waitcnt lgkmcnt(0)
    v_exp_f32 v72, v72
    v_exp_f32 v73, v73
    v_mfma_f32_32x32x16_bf16 v[40:55], v[24:27], v[36:39], v[40:55]
    ds_read_b128 v[24:27], v105 offset:24640
    v_exp_f32 v74, v74
    v_exp_f32 v75, v75
    v_exp_f32 v76, v76
    v_exp_f32 v77, v77
    v_exp_f32 v78, v78
    v_mfma_f32_32x32x16_bf16 v[56:71], v[8:11], v[4:7], 0
    ds_read_b128 v[12:15], v2 offset:56320
    v_exp_f32 v79, v79
    v_exp_f32 v80, v80
    v_cvt_pk_bf16_f32 v32, v72, v73
    v_cvt_pk_bf16_f32 v33, v74, v75
    v_cvt_pk_bf16_f32 v34, v76, v77
    v_cvt_pk_bf16_f32 v35, v78, v79
    v_exp_f32 v81, v81
    v_exp_f32 v82, v82
    v_exp_f32 v83, v83
    v_mfma_f32_32x32x16_bf16 v[40:55], v[20:23], v[32:35], v[40:55]
    ds_read_b128 v[16:19], v3 offset:24640
    v_exp_f32 v84, v84
    v_exp_f32 v85, v85
    v_exp_f32 v86, v86
    v_exp_f32 v87, v87
    v_cvt_pk_bf16_f32 v36, v80, v81
    v_cvt_pk_bf16_f32 v37, v82, v83
    v_cvt_pk_bf16_f32 v38, v84, v85
    v_cvt_pk_bf16_f32 v39, v86, v87
    s_waitcnt lgkmcnt(0)
    v_exp_f32 v56, v56
    v_exp_f32 v57, v57
    v_mfma_f32_32x32x16_bf16 v[40:55], v[28:31], v[36:39], v[40:55]
    ds_read_b128 v[28:31], v105 offset:25760
    v_exp_f32 v58, v58
    v_exp_f32 v59, v59
    v_exp_f32 v60, v60
    v_exp_f32 v61, v61
    v_exp_f32 v62, v62
    v_mfma_f32_32x32x16_bf16 v[72:87], v[12:15], v[4:7], 0
    ds_read_b128 v[8:11], v2 offset:57344
    v_exp_f32 v63, v63
    v_exp_f32 v64, v64
    v_cvt_pk_bf16_f32 v32, v56, v57
    v_cvt_pk_bf16_f32 v33, v58, v59
    v_cvt_pk_bf16_f32 v34, v60, v61
    v_cvt_pk_bf16_f32 v35, v62, v63
    v_exp_f32 v65, v65
    v_exp_f32 v66, v66
    v_exp_f32 v67, v67
    v_mfma_f32_32x32x16_bf16 v[40:55], v[16:19], v[32:35], v[40:55]
    ds_read_b128 v[20:23], v3 offset:25760
    v_exp_f32 v68, v68
    v_exp_f32 v69, v69
    v_exp_f32 v70, v70
    v_exp_f32 v71, v71
    v_cvt_pk_bf16_f32 v36, v64, v65
    v_cvt_pk_bf16_f32 v37, v66, v67
    v_cvt_pk_bf16_f32 v38, v68, v69
    v_cvt_pk_bf16_f32 v39, v70, v71
    s_waitcnt lgkmcnt(0)
    v_exp_f32 v72, v72
    v_exp_f32 v73, v73
    v_mfma_f32_32x32x16_bf16 v[40:55], v[24:27], v[36:39], v[40:55]
    ds_read_b128 v[24:27], v105 offset:26880
    v_exp_f32 v74, v74
    v_exp_f32 v75, v75
    v_exp_f32 v76, v76
    v_exp_f32 v77, v77
    v_exp_f32 v78, v78
    v_mfma_f32_32x32x16_bf16 v[56:71], v[8:11], v[4:7], 0
    ds_read_b128 v[12:15], v2 offset:58368
    v_exp_f32 v79, v79
    v_exp_f32 v80, v80
    v_cvt_pk_bf16_f32 v32, v72, v73
    v_cvt_pk_bf16_f32 v33, v74, v75
    v_cvt_pk_bf16_f32 v34, v76, v77
    v_cvt_pk_bf16_f32 v35, v78, v79
    v_exp_f32 v81, v81
    v_exp_f32 v82, v82
    v_exp_f32 v83, v83
    v_mfma_f32_32x32x16_bf16 v[40:55], v[20:23], v[32:35], v[40:55]
    ds_read_b128 v[16:19], v3 offset:26880
    v_exp_f32 v84, v84
    v_exp_f32 v85, v85
    v_exp_f32 v86, v86
    v_exp_f32 v87, v87
    v_cvt_pk_bf16_f32 v36, v80, v81
    v_cvt_pk_bf16_f32 v37, v82, v83
    v_cvt_pk_bf16_f32 v38, v84, v85
    v_cvt_pk_bf16_f32 v39, v86, v87
    s_waitcnt lgkmcnt(0)
    v_exp_f32 v56, v56
    v_exp_f32 v57, v57
    v_mfma_f32_32x32x16_bf16 v[40:55], v[28:31], v[36:39], v[40:55]
    ds_read_b128 v[28:31], v105 offset:28000
    v_exp_f32 v58, v58
    v_exp_f32 v59, v59
    v_exp_f32 v60, v60
    v_exp_f32 v61, v61
    v_exp_f32 v62, v62
    v_mfma_f32_32x32x16_bf16 v[72:87], v[12:15], v[4:7], 0
    ds_read_b128 v[8:11], v2 offset:59392
    v_exp_f32 v63, v63
    v_exp_f32 v64, v64
    v_cvt_pk_bf16_f32 v32, v56, v57
    v_cvt_pk_bf16_f32 v33, v58, v59
    v_cvt_pk_bf16_f32 v34, v60, v61
    v_cvt_pk_bf16_f32 v35, v62, v63
    v_exp_f32 v65, v65
    v_exp_f32 v66, v66
    v_exp_f32 v67, v67
    v_mfma_f32_32x32x16_bf16 v[40:55], v[16:19], v[32:35], v[40:55]
    ds_read_b128 v[20:23], v3 offset:28000
    v_exp_f32 v68, v68
    v_exp_f32 v69, v69
    v_exp_f32 v70, v70
    v_exp_f32 v71, v71
    v_cvt_pk_bf16_f32 v36, v64, v65
    v_cvt_pk_bf16_f32 v37, v66, v67
    v_cvt_pk_bf16_f32 v38, v68, v69
    v_cvt_pk_bf16_f32 v39, v70, v71
    s_waitcnt lgkmcnt(0)
    v_exp_f32 v72, v72
    v_exp_f32 v73, v73
    v_mfma_f32_32x32x16_bf16 v[40:55], v[24:27], v[36:39], v[40:55]
    ds_read_b128 v[24:27], v105 offset:29120
    v_exp_f32 v74, v74
    v_exp_f32 v75, v75
    v_exp_f32 v76, v76
    v_exp_f32 v77, v77
    v_exp_f32 v78, v78
    v_mfma_f32_32x32x16_bf16 v[56:71], v[8:11], v[4:7], 0
    ds_read_b128 v[12:15], v2 offset:60416
    v_exp_f32 v79, v79
    v_exp_f32 v80, v80
    v_cvt_pk_bf16_f32 v32, v72, v73
    v_cvt_pk_bf16_f32 v33, v74, v75
    v_cvt_pk_bf16_f32 v34, v76, v77
    v_cvt_pk_bf16_f32 v35, v78, v79
    v_exp_f32 v81, v81
    v_exp_f32 v82, v82
    v_exp_f32 v83, v83
    v_mfma_f32_32x32x16_bf16 v[40:55], v[20:23], v[32:35], v[40:55]
    ds_read_b128 v[16:19], v3 offset:29120
    v_exp_f32 v84, v84
    v_exp_f32 v85, v85
    v_exp_f32 v86, v86
    v_exp_f32 v87, v87
    v_cvt_pk_bf16_f32 v36, v80, v81
    v_cvt_pk_bf16_f32 v37, v82, v83
    v_cvt_pk_bf16_f32 v38, v84, v85
    v_cvt_pk_bf16_f32 v39, v86, v87
    s_waitcnt lgkmcnt(0)
    v_exp_f32 v56, v56
    v_exp_f32 v57, v57
    v_mfma_f32_32x32x16_bf16 v[40:55], v[28:31], v[36:39], v[40:55]
    ds_read_b128 v[28:31], v105 offset:30240
    v_exp_f32 v58, v58
    v_exp_f32 v59, v59
    v_exp_f32 v60, v60
    v_exp_f32 v61, v61
    v_exp_f32 v62, v62
    v_mfma_f32_32x32x16_bf16 v[72:87], v[12:15], v[4:7], 0
    ds_read_b128 v[8:11], v2 offset:61440
    v_exp_f32 v63, v63
    v_exp_f32 v64, v64
    v_cvt_pk_bf16_f32 v32, v56, v57
    v_cvt_pk_bf16_f32 v33, v58, v59
    v_cvt_pk_bf16_f32 v34, v60, v61
    v_cvt_pk_bf16_f32 v35, v62, v63
    v_exp_f32 v65, v65
    v_exp_f32 v66, v66
    v_exp_f32 v67, v67
    v_mfma_f32_32x32x16_bf16 v[40:55], v[16:19], v[32:35], v[40:55]
    ds_read_b128 v[20:23], v3 offset:30240
    v_exp_f32 v68, v68
    v_exp_f32 v69, v69
    v_exp_f32 v70, v70
    v_exp_f32 v71, v71
    v_cvt_pk_bf16_f32 v36, v64, v65
    v_cvt_pk_bf16_f32 v37, v66, v67
    v_cvt_pk_bf16_f32 v38, v68, v69
    v_cvt_pk_bf16_f32 v39, v70, v71
    s_waitcnt lgkmcnt(0)
    v_exp_f32 v72, v72
    v_exp_f32 v73, v73
    v_mfma_f32_32x32x16_bf16 v[40:55], v[24:27], v[36:39], v[40:55]
    ds_read_b128 v[24:27], v105 offset:31360
    v_exp_f32 v74, v74
    v_exp_f32 v75, v75
    v_exp_f32 v76, v76
    v_exp_f32 v77, v77
    v_exp_f32 v78, v78
    v_mfma_f32_32x32x16_bf16 v[56:71], v[8:11], v[4:7], 0
    ds_read_b128 v[12:15], v2 offset:62464
    v_exp_f32 v79, v79
    v_exp_f32 v80, v80
    v_cvt_pk_bf16_f32 v32, v72, v73
    v_cvt_pk_bf16_f32 v33, v74, v75
    v_cvt_pk_bf16_f32 v34, v76, v77
    v_cvt_pk_bf16_f32 v35, v78, v79
    v_exp_f32 v81, v81
    v_exp_f32 v82, v82
    v_exp_f32 v83, v83
    v_mfma_f32_32x32x16_bf16 v[40:55], v[20:23], v[32:35], v[40:55]
    ds_read_b128 v[16:19], v3 offset:31360
    v_exp_f32 v84, v84
    v_exp_f32 v85, v85
    v_exp_f32 v86, v86
    v_exp_f32 v87, v87
    v_cvt_pk_bf16_f32 v36, v80, v81
    v_cvt_pk_bf16_f32 v37, v82, v83
    v_cvt_pk_bf16_f32 v38, v84, v85
    v_cvt_pk_bf16_f32 v39, v86, v87
    s_waitcnt lgkmcnt(0)
    v_exp_f32 v56, v56
    v_exp_f32 v57, v57
    v_mfma_f32_32x32x16_bf16 v[40:55], v[28:31], v[36:39], v[40:55]
    ds_read_b128 v[28:31], v105 offset:32480
    v_exp_f32 v58, v58
    v_exp_f32 v59, v59
    v_exp_f32 v60, v60
    v_exp_f32 v61, v61
    v_exp_f32 v62, v62
    v_mfma_f32_32x32x16_bf16 v[72:87], v[12:15], v[4:7], 0
    ds_read_b128 v[8:11], v2 offset:63488
    v_exp_f32 v63, v63
    v_exp_f32 v64, v64
    v_cvt_pk_bf16_f32 v32, v56, v57
    v_cvt_pk_bf16_f32 v33, v58, v59
    v_cvt_pk_bf16_f32 v34, v60, v61
    v_cvt_pk_bf16_f32 v35, v62, v63
    v_exp_f32 v65, v65
    v_exp_f32 v66, v66
    v_exp_f32 v67, v67
    v_mfma_f32_32x32x16_bf16 v[40:55], v[16:19], v[32:35], v[40:55]
    ds_read_b128 v[20:23], v3 offset:32480
    v_exp_f32 v68, v68
    v_exp_f32 v69, v69
    v_exp_f32 v70, v70
    v_exp_f32 v71, v71
    v_cvt_pk_bf16_f32 v36, v64, v65
    v_cvt_pk_bf16_f32 v37, v66, v67
    v_cvt_pk_bf16_f32 v38, v68, v69
    v_cvt_pk_bf16_f32 v39, v70, v71
    s_waitcnt lgkmcnt(0)
    v_exp_f32 v72, v72
    v_exp_f32 v73, v73
    v_mfma_f32_32x32x16_bf16 v[40:55], v[24:27], v[36:39], v[40:55]
    ds_read_b128 v[24:27], v105 offset:33600
    v_exp_f32 v74, v74
    v_exp_f32 v75, v75
    v_exp_f32 v76, v76
    v_exp_f32 v77, v77
    v_exp_f32 v78, v78
    v_mfma_f32_32x32x16_bf16 v[56:71], v[8:11], v[4:7], 0
    ds_read_b128 v[12:15], v2 offset:64512
    v_exp_f32 v79, v79
    v_exp_f32 v80, v80
    v_cvt_pk_bf16_f32 v32, v72, v73
    v_cvt_pk_bf16_f32 v33, v74, v75
    v_cvt_pk_bf16_f32 v34, v76, v77
    v_cvt_pk_bf16_f32 v35, v78, v79
    v_exp_f32 v81, v81
    v_exp_f32 v82, v82
    v_exp_f32 v83, v83
    v_mfma_f32_32x32x16_bf16 v[40:55], v[20:23], v[32:35], v[40:55]
    ds_read_b128 v[16:19], v3 offset:33600
    v_exp_f32 v84, v84
    v_exp_f32 v85, v85
    v_exp_f32 v86, v86
    v_exp_f32 v87, v87
    v_cvt_pk_bf16_f32 v36, v80, v81
    v_cvt_pk_bf16_f32 v37, v82, v83
    v_cvt_pk_bf16_f32 v38, v84, v85
    v_cvt_pk_bf16_f32 v39, v86, v87
    s_waitcnt lgkmcnt(0)
    v_exp_f32 v56, v56
    v_exp_f32 v57, v57
    v_mfma_f32_32x32x16_bf16 v[40:55], v[28:31], v[36:39], v[40:55]
    ds_read_b128 v[28:31], v105 offset:34720
    v_exp_f32 v58, v58
    v_exp_f32 v59, v59
    v_exp_f32 v60, v60
    v_exp_f32 v61, v61
    v_exp_f32 v62, v62
    v_mfma_f32_32x32x16_bf16 v[72:87], v[12:15], v[4:7], 0
    v_exp_f32 v63, v63
    v_exp_f32 v64, v64
    v_cvt_pk_bf16_f32 v32, v56, v57
    v_cvt_pk_bf16_f32 v33, v58, v59
    v_cvt_pk_bf16_f32 v34, v60, v61
    v_cvt_pk_bf16_f32 v35, v62, v63
    v_exp_f32 v65, v65
    v_exp_f32 v66, v66
    v_exp_f32 v67, v67
    v_mfma_f32_32x32x16_bf16 v[40:55], v[16:19], v[32:35], v[40:55]
    ds_read_b128 v[20:23], v3 offset:34720
    v_exp_f32 v68, v68
    v_exp_f32 v69, v69
    v_exp_f32 v70, v70
    v_exp_f32 v71, v71
    v_cvt_pk_bf16_f32 v36, v64, v65
    v_cvt_pk_bf16_f32 v37, v66, v67
    v_cvt_pk_bf16_f32 v38, v68, v69
    v_cvt_pk_bf16_f32 v39, v70, v71
    s_waitcnt lgkmcnt(0)
    v_exp_f32 v72, v72
    v_exp_f32 v73, v73
    v_mfma_f32_32x32x16_bf16 v[40:55], v[24:27], v[36:39], v[40:55]
    v_exp_f32 v74, v74
    v_exp_f32 v75, v75
    v_exp_f32 v76, v76
    v_exp_f32 v77, v77
    v_exp_f32 v78, v78
    v_exp_f32 v79, v79
    v_exp_f32 v80, v80
    v_cvt_pk_bf16_f32 v32, v72, v73
    v_cvt_pk_bf16_f32 v33, v74, v75
    v_cvt_pk_bf16_f32 v34, v76, v77
    v_cvt_pk_bf16_f32 v35, v78, v79
    v_exp_f32 v81, v81
    v_exp_f32 v82, v82
    v_exp_f32 v83, v83
    v_mfma_f32_32x32x16_bf16 v[40:55], v[20:23], v[32:35], v[40:55]
    v_exp_f32 v84, v84
    v_exp_f32 v85, v85
    v_exp_f32 v86, v86
    v_exp_f32 v87, v87
    v_cvt_pk_bf16_f32 v36, v80, v81
    v_cvt_pk_bf16_f32 v37, v82, v83
    v_cvt_pk_bf16_f32 v38, v84, v85
    v_cvt_pk_bf16_f32 v39, v86, v87
    s_waitcnt lgkmcnt(0)
    s_nop 0
    v_mfma_f32_32x32x16_bf16 v[40:55], v[28:31], v[36:39], v[40:55]
    s_nop 11
    v_mov_b32 v105, 0x1f800000
    v_mov_b32 v106, 0x5f800000
    v_cmp_le_f32 vcc, v105, v48
    v_cmp_le_f32 s[36:37], v48, v106
    v_mov_b32 v105, 0x7f800000
    s_nop 0
    s_and_b64 vcc, vcc, s[36:37]
    v_cmp_lt_f32 s[36:37], abs(v40), v105
    s_nop 1
    s_and_b64 vcc, vcc, s[36:37]
    v_cmp_lt_f32 s[36:37], abs(v41), v105
    s_nop 1
    s_and_b64 vcc, vcc, s[36:37]
    v_cmp_lt_f32 s[36:37], abs(v42), v105
    s_nop 1
    s_and_b64 vcc, vcc, s[36:37]
    v_cmp_lt_f32 s[36:37], abs(v43), v105
    s_nop 1
    s_and_b64 vcc, vcc, s[36:37]
    v_cmp_lt_f32 s[36:37], abs(v44), v105
    s_nop 1
    s_and_b64 vcc, vcc, s[36:37]
    v_cmp_lt_f32 s[36:37], abs(v45), v105
    s_nop 1
    s_and_b64 vcc, vcc, s[36:37]
    v_cmp_lt_f32 s[36:37], abs(v46), v105
    s_nop 1
    s_and_b64 vcc, vcc, s[36:37]
    v_cmp_lt_f32 s[36:37], abs(v47), v105
    s_nop 1
    s_and_b64 vcc, vcc, s[36:37]
    s_not_b64 s[36:37], vcc
    s_cmp_eq_u64 s[36:37], 0
    s_cbranch_scc0 k2_fallback
k2_fin:
    v_rcp_f32 v105, v48
    s_nop 0
    v_mul_f32 v40, v40, v105
    v_mul_f32 v41, v41, v105
    v_mul_f32 v42, v42, v105
    v_mul_f32 v43, v43, v105
    v_mul_f32 v44, v44, v105
    v_mul_f32 v45, v45, v105
    v_mul_f32 v46, v46, v105
    v_mul_f32 v47, v47, v105
    v_cvt_pk_bf16_f32 v108, v40, v41
    v_cvt_pk_bf16_f32 v109, v42, v43
    v_cvt_pk_bf16_f32 v110, v44, v45
    v_cvt_pk_bf16_f32 v111, v46, v47
    s_lshl_b32 s32, s29, 5
    s_add_u32 s32, s32, s25
    s_lshl_b32 s32, s32, 10
    s_add_u32 s32, s32, 6291456
    buffer_store_dwordx4 v[108:111], v104, s[12:15], s32 offen sc1
    s_branch k2_proj
at_spin_44:
    s_mov_b32 s33, 0
spl_48:
    ds_read_b32 v114, v112 offset:8
    s_waitcnt lgkmcnt(0)
    v_readfirstlane_b32 s34, v114
    s_add_u32 s33, s33, 1
    s_nop 2
    s_cmp_ge_u32 s34, 8
    s_cbranch_scc1 spld_49
    s_cmp_ge_u32 s33, 0x400000
    s_cbranch_scc1 spld_49
    s_sleep 1
    s_branch spl_48
spld_49:
    s_branch at_back_45
at_spin_46:
    s_mov_b32 s33, 0
spl_50:
    ds_read_b32 v114, v112 offset:12
    s_waitcnt lgkmcnt(0)
    v_readfirstlane_b32 s34, v114
    s_add_u32 s33, s33, 1
    s_nop 2
    s_cmp_ge_u32 s34, 4
    s_cbranch_scc1 spld_51
    s_cmp_ge_u32 s33, 0x400000
    s_cbranch_scc1 spld_51
    s_sleep 1
    s_branch spl_50
spld_51:
    s_branch at_back_47
k2_fallback:
    v_mov_b32 v105, 0xff800000
    v_mov_b32 v2, v104
    s_mov_b32 s38, 0
k2_maxloop:
    ds_read_b128 v[8:11], v2
    s_waitcnt lgkmcnt(0)
    v_mfma_f32_32x32x16_bf16 v[56:71], v[8:11], v[4:7], 0
    s_nop 13
    v_max3_f32 v105, v105, v56, v57
    v_max3_f32 v105, v105, v58, v59
    v_max3_f32 v105, v105, v60, v61
    v_max3_f32 v105, v105, v62, v63
    v_max3_f32 v105, v105, v64, v65
    v_max3_f32 v105, v105, v66, v67
    v_max3_f32 v105, v105, v68, v69
    v_max3_f32 v105, v105, v70, v71
    v_add_u32 v2, 1024, v2
    s_add_u32 s38, s38, 1
    s_cmp_lt_u32 s38, 64
    s_cbranch_scc1 k2_maxloop
    v_mov_b32 v106, v105
    s_nop 1
    v_permlane32_swap_b32 v105, v106
    s_nop 1
    v_max_f32 v105, v105, v106
    v_sub_f32 v88, 0, v105
    v_sub_f32 v89, 0, v105
    v_sub_f32 v90, 0, v105
    v_sub_f32 v91, 0, v105
    v_sub_f32 v92, 0, v105
    v_sub_f32 v93, 0, v105
    v_sub_f32 v94, 0, v105
    v_sub_f32 v95, 0, v105
    v_sub_f32 v96, 0, v105
    v_sub_f32 v97, 0, v105
    v_sub_f32 v98, 0, v105
    v_sub_f32 v99, 0, v105
    v_sub_f32 v100, 0, v105
    v_sub_f32 v101, 0, v105
    v_sub_f32 v102, 0, v105
    v_sub_f32 v103, 0, v105
    v_mov_b32 v2, v104
    v_mov_b32 v3, v110
    v_mov_b32 v105, v111
    ds_read_b128 v[8:11], v2
    ds_read_b128 v[12:15], v2 offset:1024
    ds_read_b128 v[16:19], v3
    ds_read_b128 v[24:27], v105
    v_mov_b32 v40, 0
    v_mov_b32 v41, 0
    v_mov_b32 v42, 0
    v_mov_b32 v43, 0
    v_mov_b32 v44, 0
    v_mov_b32 v45, 0
    v_mov_b32 v46, 0
    v_mov_b32 v47, 0
    v_mov_b32 v48, 0
    v_mov_b32 v49, 0
    v_mov_b32 v50, 0
    v_mov_b32 v51, 0
    v_mov_b32 v52, 0
    v_mov_b32 v53, 0
    v_mov_b32 v54, 0
    v_mov_b32 v55, 0
    v_mov_b32 v32, 0
    v_mov_b32 v33, 0
    v_mov_b32 v34, 0
    v_mov_b32 v35, 0
    v_mov_b32 v36, 0
    v_mov_b32 v37, 0
    v_mov_b32 v38, 0
    v_mov_b32 v39, 0
    v_mov_b32 v28, 0
    v_mov_b32 v29, 0
    v_mov_b32 v30, 0
    v_mov_b32 v31, 0
    s_waitcnt lgkmcnt(3)
    v_mfma_f32_32x32x16_bf16 v[56:71], v[8:11], v[4:7], v[88:103]
    s_nop 11
    s_mov_b32 s38, 0
k2_exloop:
    s_waitcnt lgkmcnt(0)
    v_exp_f32 v56, v56
    v_exp_f32 v57, v57
    v_mfma_f32_32x32x16_bf16 v[40:55], v[28:31], v[36:39], v[40:55]
    ds_read_b128 v[28:31], v105 offset:1120
    v_exp_f32 v58, v58
    v_exp_f32 v59, v59
    v_exp_f32 v60, v60
    v_exp_f32 v61, v61
    v_exp_f32 v62, v62
    v_mfma_f32_32x32x16_bf16 v[72:87], v[12:15], v[4:7], v[88:103]
    ds_read_b128 v[8:11], v2 offset:2048
    v_exp_f32 v63, v63
    v_exp_f32 v64, v64
    v_cvt_pk_bf16_f32 v32, v56, v57
    v_cvt_pk_bf16_f32 v33, v58, v59
    v_cvt_pk_bf16_f32 v34, v60, v61
    v_cvt_pk_bf16_f32 v35, v62, v63
    v_exp_f32 v65, v65
    v_exp_f32 v66, v66
    v_exp_f32 v67, v67
    v_mfma_f32_32x32x16_bf16 v[40:55], v[16:19], v[32:35], v[40:55]
    ds_read_b128 v[20:23], v3 offset:1120
    v_exp_f32 v68, v68
    v_exp_f32 v69, v69
    v_exp_f32 v70, v70
    v_exp_f32 v71, v71
    v_cvt_pk_bf16_f32 v36, v64, v65
    v_cvt_pk_bf16_f32 v37, v66, v67
    v_cvt_pk_bf16_f32 v38, v68, v69
    v_cvt_pk_bf16_f32 v39, v70, v71
    s_waitcnt lgkmcnt(0)
    v_exp_f32 v72, v72
    v_exp_f32 v73, v73
    v_mfma_f32_32x32x16_bf16 v[40:55], v[24:27], v[36:39], v[40:55]
    ds_read_b128 v[24:27], v105 offset:2240
    v_exp_f32 v74, v74
    v_exp_f32 v75, v75
    v_exp_f32 v76, v76
    v_exp_f32 v77, v77
    v_exp_f32 v78, v78
    v_mfma_f32_32x32x16_bf16 v[56:71], v[8:11], v[4:7], v[88:103]
    ds_read_b128 v[12:15], v2 offset:3072
    v_exp_f32 v79, v79
    v_exp_f32 v80, v80
    v_cvt_pk_bf16_f32 v32, v72, v73
    v_cvt_pk_bf16_f32 v33, v74, v75
    v_cvt_pk_bf16_f32 v34, v76, v77
    v_cvt_pk_bf16_f32 v35, v78, v79
    v_exp_f32 v81, v81
    v_exp_f32 v82, v82
    v_exp_f32 v83, v83
    v_mfma_f32_32x32x16_bf16 v[40:55], v[20:23], v[32:35], v[40:55]
    ds_read_b128 v[16:19], v3 offset:2240
    v_exp_f32 v84, v84
    v_exp_f32 v85, v85
    v_exp_f32 v86, v86
    v_exp_f32 v87, v87
    v_cvt_pk_bf16_f32 v36, v80, v81
    v_cvt_pk_bf16_f32 v37, v82, v83
    v_cvt_pk_bf16_f32 v38, v84, v85
    v_cvt_pk_bf16_f32 v39, v86, v87
    v_add_u32 v2, 2048, v2
    v_add_u32 v3, 2240, v3
    v_add_u32 v105, 2240, v105
    s_add_u32 s38, s38, 1
    s_cmp_lt_u32 s38, 32
    s_cbranch_scc1 k2_exloop
    s_waitcnt lgkmcnt(0)
    s_nop 0
    v_mfma_f32_32x32x16_bf16 v[40:55], v[28:31], v[36:39], v[40:55]
    s_nop 11
    s_branch k2_fin
k2_proj:
    s_waitcnt vmcnt(0)
    s_barrier
    s_cmp_lg_u32 s24, 0
    s_cbranch_scc1 pj_nosig_52
    s_add_u32 s33, s26, 16
    s_lshl_b32 s33, s33, 12
    s_add_u32 s33, s33, 12582912
    v_mov_b32 v2, s33
    v_mov_b32 v3, 1
    s_mov_b64 exec, 1
    buffer_atomic_add v3, v2, s[12:15], 0 offen
    s_mov_b64 exec, -1
pj_nosig_52:
    s_lshl_b32 s33, s26, 3
    s_lshr_b32 s34, s25, 2
    s_and_b32 s34, s34, 7
    s_add_u32 s33, s33, s34
    s_and_b32 s34, s25, 3
    s_cmp_lt_u32 s24, 4
    s_cbranch_scc1 k2_pj_comp
    s_sub_u32 s35, s24, 4
    s_load_dwordx2 s[4:5], s[0:1], 16
    v_lshrrev_b32 v2, 4, v1
    v_lshlrev_b32 v3, 2, v2
    v_xor_b32 v3, v3, v1
    v_and_b32 v3, 15, v3
    v_lshlrev_b32 v3, 4, v3
    v_lshlrev_b32 v2, 10, v2
    v_add_u32 v2, v2, v3
    s_lshl_b32 s38, s35, 17
    s_lshl_b32 s39, s34, 8
    s_add_u32 s38, s38, s39
    s_lshl_b32 s39, s35, 15
    s_add_u32 s39, s39, 32768
    s_waitcnt lgkmcnt(0)
    s_mov_b32 s16, s4
    s_and_b32 s17, s5, 0xffff
    s_mov_b32 s18, 0x80000
    s_mov_b32 s19, 0x20000
    s_add_u32 m0, s39, 0
    s_nop 0
    buffer_load_dwordx4 v2, s[16:19], s38 offen lds
    s_add_u32 s38, s38, 4096
    s_add_u32 m0, s39, 1024
    s_nop 0
    buffer_load_dwordx4 v2, s[16:19], s38 offen lds
    s_add_u32 s38, s38, 4096
    s_add_u32 m0, s39, 2048
    s_nop 0
    buffer_load_dwordx4 v2, s[16:19], s38 offen lds
    s_add_u32 s38, s38, 4096
    s_add_u32 m0, s39, 3072
    s_nop 0
    buffer_load_dwordx4 v2, s[16:19], s38 offen lds
    s_add_u32 s38, s38, 4096
    s_add_u32 m0, s39, 4096
    s_nop 0
    buffer_load_dwordx4 v2, s[16:19], s38 offen lds
    s_add_u32 s38, s38, 4096
    s_add_u32 m0, s39, 5120
    s_nop 0
    buffer_load_dwordx4 v2, s[16:19], s38 offen lds
    s_add_u32 s38, s38, 4096
    s_add_u32 m0, s39, 6144
    s_nop 0
    buffer_load_dwordx4 v2, s[16:19], s38 offen lds
    s_add_u32 s38, s38, 4096
    s_add_u32 m0, s39, 7168
    s_nop 0
    buffer_load_dwordx4 v2, s[16:19], s38 offen lds
    s_add_u32 s38, s38, 4096
    s_add_u32 m0, s39, 8192
    s_nop 0
    buffer_load_dwordx4 v2, s[16:19], s38 offen lds
    s_add_u32 s38, s38, 4096
    s_add_u32 m0, s39, 9216
    s_nop 0
    buffer_load_dwordx4 v2, s[16:19], s38 offen lds
    s_add_u32 s38, s38, 4096
    s_add_u32 m0, s39, 10240
    s_nop 0
    buffer_load_dwordx4 v2, s[16:19], s38 offen lds
    s_add_u32 s38, s38, 4096
    s_add_u32 m0, s39, 11264
    s_nop 0
    buffer_load_dwordx4 v2, s[16:19], s38 offen lds
    s_add_u32 s38, s38, 4096
    s_add_u32 m0, s39, 12288
    s_nop 0
    buffer_load_dwordx4 v2, s[16:19], s38 offen lds
    s_add_u32 s38, s38, 4096
    s_add_u32 m0, s39, 13312
    s_nop 0
    buffer_load_dwordx4 v2, s[16:19], s38 offen lds
    s_add_u32 s38, s38, 4096
    s_add_u32 m0, s39, 14336
    s_nop 0
    buffer_load_dwordx4 v2, s[16:19], s38 offen lds
    s_add_u32 s38, s38, 4096
    s_add_u32 m0, s39, 15360
    s_nop 0
    buffer_load_dwordx4 v2, s[16:19], s38 offen lds
    s_add_u32 s38, s38, 4096
    s_add_u32 m0, s39, 16384
    s_nop 0
    buffer_load_dwordx4 v2, s[16:19], s38 offen lds
    s_add_u32 s38, s38, 4096
    s_add_u32 m0, s39, 17408
    s_nop 0
    buffer_load_dwordx4 v2, s[16:19], s38 offen lds
    s_add_u32 s38, s38, 4096
    s_add_u32 m0, s39, 18432
    s_nop 0
    buffer_load_dwordx4 v2, s[16:19], s38 offen lds
    s_add_u32 s38, s38, 4096
    s_add_u32 m0, s39, 19456
    s_nop 0
    buffer_load_dwordx4 v2, s[16:19], s38 offen lds
    s_add_u32 s38, s38, 4096
    s_add_u32 m0, s39, 20480
    s_nop 0
    buffer_load_dwordx4 v2, s[16:19], s38 offen lds
    s_add_u32 s38, s38, 4096
    s_add_u32 m0, s39, 21504
    s_nop 0
    buffer_load_dwordx4 v2, s[16:19], s38 offen lds
    s_add_u32 s38, s38, 4096
    s_add_u32 m0, s39, 22528
    s_nop 0
    buffer_load_dwordx4 v2, s[16:19], s38 offen lds
    s_add_u32 s38, s38, 4096
    s_add_u32 m0, s39, 23552
    s_nop 0
    buffer_load_dwordx4 v2, s[16:19], s38 offen lds
    s_add_u32 s38, s38, 4096
    s_add_u32 m0, s39, 24576
    s_nop 0
    buffer_load_dwordx4 v2, s[16:19], s38 offen lds
    s_add_u32 s38, s38, 4096
    s_add_u32 m0, s39, 25600
    s_nop 0
    buffer_load_dwordx4 v2, s[16:19], s38 offen lds
    s_add_u32 s38, s38, 4096
    s_add_u32 m0, s39, 26624
    s_nop 0
    buffer_load_dwordx4 v2, s[16:19], s38 offen lds
    s_add_u32 s38, s38, 4096
    s_add_u32 m0, s39, 27648
    s_nop 0
    buffer_load_dwordx4 v2, s[16:19], s38 offen lds
    s_add_u32 s38, s38, 4096
    s_add_u32 m0, s39, 28672
    s_nop 0
    buffer_load_dwordx4 v2, s[16:19], s38 offen lds
    s_add_u32 s38, s38, 4096
    s_add_u32 m0, s39, 29696
    s_nop 0
    buffer_load_dwordx4 v2, s[16:19], s38 offen lds
    s_add_u32 s38, s38, 4096
    s_add_u32 m0, s39, 30720
    s_nop 0
    buffer_load_dwordx4 v2, s[16:19], s38 offen lds
    s_add_u32 s38, s38, 4096
    s_add_u32 m0, s39, 31744
    s_nop 0
    buffer_load_dwordx4 v2, s[16:19], s38 offen lds
    s_add_u32 s38, s38, 4096
    s_waitcnt vmcnt(0)
    s_barrier
    s_cmp_lg_u32 s24, 4
    s_cbranch_scc1 pj_nopoll_53
    s_add_u32 s40, s26, 16
    s_lshl_b32 s40, s40, 12
    s_add_u32 s40, s40, 12582912
    v_mov_b32 v4, 0
    s_mov_b32 s41, 0
spg_54:
    buffer_load_dword v5, v4, s[12:15], s40 offen sc1
    s_waitcnt vmcnt(0)
    v_readfirstlane_b32 s42, v5
    s_add_u32 s41, s41, 1
    s_nop 2
    s_cmp_ge_u32 s42, 32
    s_cbranch_scc1 spgd_55
    s_cmp_ge_u32 s41, 0x80000
    s_cbranch_scc1 spgd_55
    s_sleep 1
    s_branch spg_54
spgd_55:
pj_nopoll_53:
    s_barrier
    s_lshl_b32 s38, s33, 5
    s_lshl_b32 s40, s35, 1
    s_add_u32 s38, s38, s40
    s_lshl_b32 s38, s38, 10
    s_add_u32 s38, s38, 6291456
    s_lshl_b32 s39, s35, 11
    s_add_u32 m0, s39, 0
    s_add_u32 s40, s38, 0
    buffer_load_dwordx4 v104, s[12:15], s40 offen sc1 lds
    s_add_u32 m0, s39, 1024
    s_add_u32 s40, s38, 1024
    buffer_load_dwordx4 v104, s[12:15], s40 offen sc1 lds
    s_add_u32 m0, s39, 8192
    s_add_u32 s40, s38, 8192
    buffer_load_dwordx4 v104, s[12:15], s40 offen sc1 lds
    s_add_u32 m0, s39, 9216
    s_add_u32 s40, s38, 9216
    buffer_load_dwordx4 v104, s[12:15], s40 offen sc1 lds
    s_add_u32 m0, s39, 16384
    s_add_u32 s40, s38, 16384
    buffer_load_dwordx4 v104, s[12:15], s40 offen sc1 lds
    s_add_u32 m0, s39, 17408
    s_add_u32 s40, s38, 17408
    buffer_load_dwordx4 v104, s[12:15], s40 offen sc1 lds
    s_add_u32 m0, s39, 24576
    s_add_u32 s40, s38, 24576
    buffer_load_dwordx4 v104, s[12:15], s40 offen sc1 lds
    s_add_u32 m0, s39, 25600
    s_add_u32 s40, s38, 25600
    buffer_load_dwordx4 v104, s[12:15], s40 offen sc1 lds
    s_waitcnt vmcnt(4)
    s_barrier
    s_waitcnt vmcnt(0)
    s_barrier
    s_endpgm
k2_pj_comp:
    v_lshrrev_b32 v4, 5, v1
    v_lshlrev_b32 v4, 3, v4
    v_bfe_u32 v5, v1, 2, 2
    v_add_u32 v4, v4, v5
    v_lshlrev_b32 v4, 8, v4
    v_xor_b32 v5, s24, v5
    v_lshlrev_b32 v5, 6, v5
    v_add_u32 v4, v4, v5
    v_bfe_u32 v5, v1, 4, 1
    v_lshlrev_b32 v5, 1, v5
    v_bfe_u32 v6, v1, 1, 1
    v_add_u32 v5, v5, v6
    v_and_b32 v6, 1, v1
    v_lshlrev_b32 v6, 2, v6
    v_add_u32 v5, v5, v6
    v_lshlrev_b32 v5, 3, v5
    v_add_u32 v4, v4, v5
    v_add_u32 v4, 32768, v4
    v_add_u32 v7, 0x10000, v4
    s_lshl_b32 s37, s33, 16
    s_lshl_b32 s38, s24, 6
    s_lshl_b32 s39, s34, 8
    s_add_u32 s38, s38, s39
    s_add_u32 s37, s37, s38
    v_and_b32 v5, 31, v1
    v_lshlrev_b32 v5, 11, v5
    v_lshrrev_b32 v6, 5, v1
    v_lshlrev_b32 v6, 5, v6
    v_add_u32 v5, v5, v6
    v_mov_b32 v3, v104
    s_barrier
    ds_read_b64_tr_b16 v[24:25], v4 offset:0
    ds_read_b64_tr_b16 v[26:27], v4 offset:1024
    ds_read_b64_tr_b16 v[28:29], v4 offset:4096
    ds_read_b64_tr_b16 v[30:31], v4 offset:5120
    ds_read_b64_tr_b16 v[32:33], v4 offset:8192
    ds_read_b64_tr_b16 v[34:35], v4 offset:9216
    ds_read_b64_tr_b16 v[36:37], v4 offset:12288
    ds_read_b64_tr_b16 v[38:39], v4 offset:13312
    ds_read_b64_tr_b16 v[40:41], v4 offset:16384
    ds_read_b64_tr_b16 v[42:43], v4 offset:17408
    ds_read_b64_tr_b16 v[44:45], v4 offset:20480
    ds_read_b64_tr_b16 v[46:47], v4 offset:21504
    s_waitcnt lgkmcnt(2)
    ds_read_b64_tr_b16 v[48:49], v4 offset:24576
    ds_read_b64_tr_b16 v[50:51], v4 offset:25600
    ds_read_b64_tr_b16 v[52:53], v4 offset:28672
    ds_read_b64_tr_b16 v[54:55], v4 offset:29696
    ds_read_b64_tr_b16 v[56:57], v4 offset:32768
    ds_read_b64_tr_b16 v[58:59], v4 offset:33792
    ds_read_b64_tr_b16 v[60:61], v4 offset:36864
    ds_read_b64_tr_b16 v[62:63], v4 offset:37888
    ds_read_b64_tr_b16 v[64:65], v4 offset:40960
    ds_read_b64_tr_b16 v[66:67], v4 offset:41984
    ds_read_b64_tr_b16 v[68:69], v4 offset:45056
    ds_read_b64_tr_b16 v[70:71], v4 offset:46080
    s_waitcnt lgkmcnt(2)
    ds_read_b64_tr_b16 v[72:73], v4 offset:49152
    ds_read_b64_tr_b16 v[74:75], v4 offset:50176
    ds_read_b64_tr_b16 v[76:77], v4 offset:53248
    ds_read_b64_tr_b16 v[78:79], v4 offset:54272
    ds_read_b64_tr_b16 v[80:81], v4 offset:57344
    ds_read_b64_tr_b16 v[82:83], v4 offset:58368
    ds_read_b64_tr_b16 v[84:85], v4 offset:61440
    ds_read_b64_tr_b16 v[86:87], v4 offset:62464
    ds_read_b64_tr_b16 v[88:89], v7 offset:0
    ds_read_b64_tr_b16 v[90:91], v7 offset:1024
    ds_read_b64_tr_b16 v[92:93], v7 offset:4096
    ds_read_b64_tr_b16 v[94:95], v7 offset:5120
    s_waitcnt lgkmcnt(2)
    ds_read_b64_tr_b16 v[96:97], v7 offset:8192
    ds_read_b64_tr_b16 v[98:99], v7 offset:9216
    ds_read_b64_tr_b16 v[100:101], v7 offset:12288
    ds_read_b64_tr_b16 v[102:103], v7 offset:13312
    ds_read_b64_tr_b16 v[104:105], v7 offset:16384
    ds_read_b64_tr_b16 v[106:107], v7 offset:17408
    ds_read_b64_tr_b16 v[108:109], v7 offset:20480
    ds_read_b64_tr_b16 v[110:111], v7 offset:21504
    ds_read_b64_tr_b16 v[112:113], v7 offset:24576
    ds_read_b64_tr_b16 v[114:115], v7 offset:25600
    ds_read_b64_tr_b16 v[116:117], v7 offset:28672
    ds_read_b64_tr_b16 v[118:119], v7 offset:29696
    s_waitcnt lgkmcnt(2)
    s_waitcnt lgkmcnt(0)
    s_barrier
    s_barrier
    ds_read_b128 v[120:123], v3 offset:0
    ds_read_b128 v[124:127], v3 offset:1024
    ds_read_b128 v[128:131], v3 offset:2048
    ds_read_b128 v[132:135], v3 offset:3072
    ds_read_b128 v[136:139], v3 offset:4096
    ds_read_b128 v[140:143], v3 offset:5120
    ds_read_b128 v[144:147], v3 offset:6144
    ds_read_b128 v[148:151], v3 offset:7168
    s_waitcnt lgkmcnt(7)
    v_mfma_f32_32x32x16_bf16 v[8:23], v[24:27], v[120:123], 0
    ds_read_b128 v[120:123], v3 offset:8192
    s_waitcnt lgkmcnt(7)
    v_mfma_f32_32x32x16_bf16 v[8:23], v[28:31], v[124:127], v[8:23]
    ds_read_b128 v[124:127], v3 offset:9216
    s_waitcnt lgkmcnt(7)
    v_mfma_f32_32x32x16_bf16 v[8:23], v[32:35], v[128:131], v[8:23]
    ds_read_b128 v[128:131], v3 offset:10240
    s_waitcnt lgkmcnt(7)
    v_mfma_f32_32x32x16_bf16 v[8:23], v[36:39], v[132:135], v[8:23]
    ds_read_b128 v[132:135], v3 offset:11264
    s_waitcnt lgkmcnt(7)
    v_mfma_f32_32x32x16_bf16 v[8:23], v[40:43], v[136:139], v[8:23]
    ds_read_b128 v[136:139], v3 offset:12288
    s_waitcnt lgkmcnt(7)
    v_mfma_f32_32x32x16_bf16 v[8:23], v[44:47], v[140:143], v[8:23]
    ds_read_b128 v[140:143], v3 offset:13312
    s_waitcnt lgkmcnt(7)
    v_mfma_f32_32x32x16_bf16 v[8:23], v[48:51], v[144:147], v[8:23]
    ds_read_b128 v[144:147], v3 offset:14336
    s_waitcnt lgkmcnt(7)
    v_mfma_f32_32x32x16_bf16 v[8:23], v[52:55], v[148:151], v[8:23]
    ds_read_b128 v[148:151], v3 offset:15360
    s_waitcnt lgkmcnt(7)
    v_mfma_f32_32x32x16_bf16 v[8:23], v[56:59], v[120:123], v[8:23]
    s_waitcnt lgkmcnt(6)
    v_mfma_f32_32x32x16_bf16 v[8:23], v[60:63], v[124:127], v[8:23]
    s_waitcnt lgkmcnt(5)
    v_mfma_f32_32x32x16_bf16 v[8:23], v[64:67], v[128:131], v[8:23]
    s_waitcnt lgkmcnt(4)
    v_mfma_f32_32x32x16_bf16 v[8:23], v[68:71], v[132:135], v[8:23]
    s_waitcnt lgkmcnt(3)
    v_mfma_f32_32x32x16_bf16 v[8:23], v[72:75], v[136:139], v[8:23]
    s_waitcnt lgkmcnt(2)
    v_mfma_f32_32x32x16_bf16 v[8:23], v[76:79], v[140:143], v[8:23]
    s_waitcnt lgkmcnt(1)
    v_mfma_f32_32x32x16_bf16 v[8:23], v[80:83], v[144:147], v[8:23]
    s_waitcnt lgkmcnt(0)
    v_mfma_f32_32x32x16_bf16 v[8:23], v[84:87], v[148:151], v[8:23]
    ds_read_b64_tr_b16 v[24:25], v7 offset:32768
    ds_read_b64_tr_b16 v[26:27], v7 offset:33792
    ds_read_b64_tr_b16 v[28:29], v7 offset:36864
    ds_read_b64_tr_b16 v[30:31], v7 offset:37888
    ds_read_b64_tr_b16 v[32:33], v7 offset:40960
    ds_read_b64_tr_b16 v[34:35], v7 offset:41984
    ds_read_b64_tr_b16 v[36:37], v7 offset:45056
    ds_read_b64_tr_b16 v[38:39], v7 offset:46080
    ds_read_b64_tr_b16 v[40:41], v7 offset:49152
    ds_read_b64_tr_b16 v[42:43], v7 offset:50176
    ds_read_b64_tr_b16 v[44:45], v7 offset:53248
    ds_read_b64_tr_b16 v[46:47], v7 offset:54272
    ds_read_b64_tr_b16 v[48:49], v7 offset:57344
    ds_read_b64_tr_b16 v[50:51], v7 offset:58368
    ds_read_b64_tr_b16 v[52:53], v7 offset:61440
    ds_read_b64_tr_b16 v[54:55], v7 offset:62464
    s_waitcnt lgkmcnt(0)
    s_barrier
    ds_read_b128 v[120:123], v3 offset:16384
    ds_read_b128 v[124:127], v3 offset:17408
    ds_read_b128 v[128:131], v3 offset:18432
    ds_read_b128 v[132:135], v3 offset:19456
    ds_read_b128 v[136:139], v3 offset:20480
    ds_read_b128 v[140:143], v3 offset:21504
    ds_read_b128 v[144:147], v3 offset:22528
    ds_read_b128 v[148:151], v3 offset:23552
    s_waitcnt lgkmcnt(7)
    v_mfma_f32_32x32x16_bf16 v[8:23], v[88:91], v[120:123], v[8:23]
    ds_read_b128 v[120:123], v3 offset:24576
    s_waitcnt lgkmcnt(7)
    v_mfma_f32_32x32x16_bf16 v[8:23], v[92:95], v[124:127], v[8:23]
    ds_read_b128 v[124:127], v3 offset:25600
    s_waitcnt lgkmcnt(7)
    v_mfma_f32_32x32x16_bf16 v[8:23], v[96:99], v[128:131], v[8:23]
    ds_read_b128 v[128:131], v3 offset:26624
    s_waitcnt lgkmcnt(7)
    v_mfma_f32_32x32x16_bf16 v[8:23], v[100:103], v[132:135], v[8:23]
    ds_read_b128 v[132:135], v3 offset:27648
    s_waitcnt lgkmcnt(7)
    v_mfma_f32_32x32x16_bf16 v[8:23], v[104:107], v[136:139], v[8:23]
    ds_read_b128 v[136:139], v3 offset:28672
    s_waitcnt lgkmcnt(7)
    v_mfma_f32_32x32x16_bf16 v[8:23], v[108:111], v[140:143], v[8:23]
    ds_read_b128 v[140:143], v3 offset:29696
    s_waitcnt lgkmcnt(7)
    v_mfma_f32_32x32x16_bf16 v[8:23], v[112:115], v[144:147], v[8:23]
    ds_read_b128 v[144:147], v3 offset:30720
    s_waitcnt lgkmcnt(7)
    v_mfma_f32_32x32x16_bf16 v[8:23], v[116:119], v[148:151], v[8:23]
    ds_read_b128 v[148:151], v3 offset:31744
    s_waitcnt lgkmcnt(7)
    v_mfma_f32_32x32x16_bf16 v[8:23], v[24:27], v[120:123], v[8:23]
    s_waitcnt lgkmcnt(6)
    v_mfma_f32_32x32x16_bf16 v[8:23], v[28:31], v[124:127], v[8:23]
    s_waitcnt lgkmcnt(5)
    v_mfma_f32_32x32x16_bf16 v[8:23], v[32:35], v[128:131], v[8:23]
    s_waitcnt lgkmcnt(4)
    v_mfma_f32_32x32x16_bf16 v[8:23], v[36:39], v[132:135], v[8:23]
    s_waitcnt lgkmcnt(3)
    v_mfma_f32_32x32x16_bf16 v[8:23], v[40:43], v[136:139], v[8:23]
    s_waitcnt lgkmcnt(2)
    v_mfma_f32_32x32x16_bf16 v[8:23], v[44:47], v[140:143], v[8:23]
    s_waitcnt lgkmcnt(1)
    v_mfma_f32_32x32x16_bf16 v[8:23], v[48:51], v[144:147], v[8:23]
    s_waitcnt lgkmcnt(0)
    v_mfma_f32_32x32x16_bf16 v[8:23], v[52:55], v[148:151], v[8:23]
    s_nop 11
    v_cvt_pk_bf16_f32 v8, v8, v9
    v_cvt_pk_bf16_f32 v9, v10, v11
    v_cvt_pk_bf16_f32 v10, v12, v13
    v_cvt_pk_bf16_f32 v11, v14, v15
    v_cvt_pk_bf16_f32 v12, v16, v17
    v_cvt_pk_bf16_f32 v13, v18, v19
    v_cvt_pk_bf16_f32 v14, v20, v21
    v_cvt_pk_bf16_f32 v15, v22, v23
    buffer_store_dwordx4 v[8:11], v5, s[20:23], s37 offen
    buffer_store_dwordx4 v[12:15], v5, s[20:23], s37 offen offset:16
    s_endpgm
k2_conv:
    s_sub_u32 s28, s24, 8
    s_lshr_b32 s29, s28, 1
    s_and_b32 s30, s28, 1
    v_mov_b32 v112, 163328
    v_mov_b32 v113, 1
    s_mul_i32 s31, s29, 12800
    s_mul_i32 s32, s30, 5120
    s_add_u32 s31, s31, s32
    s_add_u32 s31, s31, 32768
    s_mov_b32 s35, 0
spl_56:
    ds_read_b32 v8, v112 offset:20
    s_waitcnt lgkmcnt(0)
    v_readfirstlane_b32 s34, v8
    s_add_u32 s35, s35, 1
    s_nop 2
    s_cmp_ge_u32 s34, 4
    s_cbranch_scc1 spld_57
    s_cmp_ge_u32 s35, 0x400000
    s_cbranch_scc1 spld_57
    s_sleep 1
    s_branch spl_56
spld_57:
    v_mov_b32 v4, 0
    v_mov_b32 v5, 0
    v_mov_b32 v6, 0
    v_mov_b32 v7, 0
    v_lshlrev_b32 v2, 4, v1
    v_add_u32 v3, s31, v2
    ds_write_b128 v3, v[4:7]
    ds_write_b128 v3, v[4:7] offset:1024
    s_mov_b32 exec_hi, 0
    ds_write_b128 v3, v[4:7] offset:2048
    s_mov_b64 exec, -1
    v_lshrrev_b32 v3, 2, v1
    v_lshlrev_b32 v3, 4, v3
    v_add3_u32 v3, v3, v2, s31
    v_and_b32 v24, 31, v1
    v_lshrrev_b32 v25, 5, v1
    v_bfe_u32 v29, v1, 2, 1
    v_lshlrev_b32 v29, 4, v29
    v_and_b32 v30, 3, v1
    v_add_u32 v29, v29, v30
    v_bfe_u32 v30, v1, 3, 2
    v_lshl_add_u32 v29, v30, 2, v29
    v_mul_u32_u24 v26, 80, v24
    v_lshlrev_b32 v27, 4, v25
    v_sub_u32 v26, v26, v27
    s_mul_i32 s34, s30, 2560
    s_add_u32 s34, s34, s31
    s_add_u32 s34, s34, 2176
    v_add_u32 v26, s34, v26
    v_sub_u32 v27, 3, v29
    v_and_b32 v27, 3, v27
    v_lshlrev_b32 v28, 3, v25
    v_add3_u32 v28, v28, v29, v27
    v_sub_u32 v28, 2071, v28
    v_lshlrev_b32 v28, 1, v28
    v_and_b32 v30, 1, v27
    v_mul_u32_u24 v30, 4160, v30
    v_add_u32 v28, v28, v30
    v_mov_b32 v30, 137216
    v_mov_b32 v31, 105856
    v_cmp_lt_u32 vcc, 1, v27
    s_mul_i32 s34, s29, 8320
    s_sub_u32 s34, s34, 352
    v_cndmask_b32 v30, v30, v31, vcc
    v_add3_u32 v27, v28, v30, s34
    s_waitcnt vmcnt(0)
    ds_write_b128 v3, v[136:139] offset:2560
    ds_write_b128 v3, v[140:143] offset:3840
    s_cmp_eq_u32 s30, 0
    s_cbranch_scc1 cv_t0b_58
    ds_write_b128 v3, v[144:147] offset:5120
    ds_write_b128 v3, v[148:151] offset:6400
cv_t0b_58:
    v_mov_b32 v32, 0
    v_mov_b32 v33, 0
    v_mov_b32 v34, 0
    v_mov_b32 v35, 0
    v_mov_b32 v36, 0
    v_mov_b32 v37, 0
    v_mov_b32 v38, 0
    v_mov_b32 v39, 0
    v_mov_b32 v40, 0
    v_mov_b32 v41, 0
    v_mov_b32 v42, 0
    v_mov_b32 v43, 0
    v_mov_b32 v44, 0
    v_mov_b32 v45, 0
    v_mov_b32 v46, 0
    v_mov_b32 v47, 0
    s_waitcnt lgkmcnt(0)
    ds_read_b128 v[48:51], v26 offset:432
    ds_read_b64 v[52:53], v27 offset:352
    ds_read_b64 v[54:55], v27 offset:360
    ds_read_b128 v[56:59], v26 offset:400
    ds_read_b64 v[60:61], v27 offset:320
    ds_read_b64 v[62:63], v27 offset:328
    ds_read_b128 v[64:67], v26 offset:352
    ds_read_b64 v[68:69], v27 offset:288
    ds_read_b64 v[70:71], v27 offset:296
    ds_read_b128 v[72:75], v26 offset:320
    ds_read_b64 v[76:77], v27 offset:256
    ds_read_b64 v[78:79], v27 offset:264
    s_lshl_b32 s36, s30, 2
    s_add_u32 s36, s36, 8
    s_mov_b32 s38, 0
cv_loop:
    s_waitcnt lgkmcnt(9)
    v_mfma_f32_32x32x16_bf16 v[32:47], v[52:55], v[48:51], v[32:47]
    ds_read_b128 v[48:51], v26 offset:272
    ds_read_b64 v[52:53], v27 offset:224
    ds_read_b64 v[54:55], v27 offset:232
    s_waitcnt lgkmcnt(9)
    v_mfma_f32_32x32x16_bf16 v[32:47], v[60:63], v[56:59], v[32:47]
    ds_read_b128 v[56:59], v26 offset:240
    ds_read_b64 v[60:61], v27 offset:192
    ds_read_b64 v[62:63], v27 offset:200
    s_waitcnt lgkmcnt(9)
    v_mfma_f32_32x32x16_bf16 v[32:47], v[68:71], v[64:67], v[32:47]
    ds_read_b128 v[64:67], v26 offset:192
    ds_read_b64 v[68:69], v27 offset:160
    ds_read_b64 v[70:71], v27 offset:168
    s_waitcnt lgkmcnt(9)
    v_mfma_f32_32x32x16_bf16 v[32:47], v[76:79], v[72:75], v[32:47]
    ds_read_b128 v[72:75], v26 offset:160
    ds_read_b64 v[76:77], v27 offset:128
    ds_read_b64 v[78:79], v27 offset:136
    s_waitcnt lgkmcnt(9)
    v_mfma_f32_32x32x16_bf16 v[32:47], v[52:55], v[48:51], v[32:47]
    ds_read_b128 v[48:51], v26 offset:112
    ds_read_b64 v[52:53], v27 offset:96
    ds_read_b64 v[54:55], v27 offset:104
    s_waitcnt lgkmcnt(9)
    v_mfma_f32_32x32x16_bf16 v[32:47], v[60:63], v[56:59], v[32:47]
    ds_read_b128 v[56:59], v26 offset:80
    ds_read_b64 v[60:61], v27 offset:64
    ds_read_b64 v[62:63], v27 offset:72
    s_waitcnt lgkmcnt(9)
    v_mfma_f32_32x32x16_bf16 v[32:47], v[68:71], v[64:67], v[32:47]
    ds_read_b128 v[64:67], v26 offset:32
    ds_read_b64 v[68:69], v27 offset:32
    ds_read_b64 v[70:71], v27 offset:40
    s_waitcnt lgkmcnt(9)
    v_mfma_f32_32x32x16_bf16 v[32:47], v[76:79], v[72:75], v[32:47]
    ds_read_b128 v[72:75], v26 offset:0
    ds_read_b64 v[76:77], v27 offset:0
    ds_read_b64 v[78:79], v27 offset:8
    v_subrev_u32 v26, 320, v26
    v_subrev_u32 v27, 256, v27
    s_add_u32 s38, s38, 1
    s_cmp_lt_u32 s38, s36
    s_cbranch_scc1 cv_loop
    s_waitcnt lgkmcnt(0)
    s_lshl_b32 s40, s29, 12
    s_add_u32 s40, s40, 153856
    v_add_u32 v31, s40, v2
    s_cmp_eq_u32 s30, 1
    s_cbranch_scc1 cv_t1_59
    v_add_u32 v26, 1280, v26
    v_subrev_u32 v27, 1024, v27
    v_mov_b32 v88, 0
    v_mov_b32 v89, 0
    v_mov_b32 v90, 0
    v_mov_b32 v91, 0
    v_mov_b32 v92, 0
    v_mov_b32 v93, 0
    v_mov_b32 v94, 0
    v_mov_b32 v95, 0
    v_mov_b32 v96, 0
    v_mov_b32 v97, 0
    v_mov_b32 v98, 0
    v_mov_b32 v99, 0
    v_mov_b32 v100, 0
    v_mov_b32 v101, 0
    v_mov_b32 v102, 0
    v_mov_b32 v103, 0
    ds_read_b128 v[48:51], v26 offset:432
    ds_read_b64 v[52:53], v27 offset:352
    ds_read_b64 v[54:55], v27 offset:360
    ds_read_b128 v[56:59], v26 offset:400
    ds_read_b64 v[60:61], v27 offset:320
    ds_read_b64 v[62:63], v27 offset:328
    ds_read_b128 v[64:67], v26 offset:352
    ds_read_b64 v[68:69], v27 offset:288
    ds_read_b64 v[70:71], v27 offset:296
    ds_read_b128 v[72:75], v26 offset:320
    ds_read_b64 v[76:77], v27 offset:256
    ds_read_b64 v[78:79], v27 offset:264
    s_mov_b32 s36, 4
    s_mov_b32 s38, 0
cv_loop2:
    s_waitcnt lgkmcnt(9)
    v_mfma_f32_32x32x16_bf16 v[88:103], v[52:55], v[48:51], v[88:103]
    ds_read_b128 v[48:51], v26 offset:272
    ds_read_b64 v[52:53], v27 offset:224
    ds_read_b64 v[54:55], v27 offset:232
    s_waitcnt lgkmcnt(9)
    v_mfma_f32_32x32x16_bf16 v[88:103], v[60:63], v[56:59], v[88:103]
    ds_read_b128 v[56:59], v26 offset:240
    ds_read_b64 v[60:61], v27 offset:192
    ds_read_b64 v[62:63], v27 offset:200
    s_waitcnt lgkmcnt(9)
    v_mfma_f32_32x32x16_bf16 v[88:103], v[68:71], v[64:67], v[88:103]
    ds_read_b128 v[64:67], v26 offset:192
    ds_read_b64 v[68:69], v27 offset:160
    ds_read_b64 v[70:71], v27 offset:168
    s_waitcnt lgkmcnt(9)
    v_mfma_f32_32x32x16_bf16 v[88:103], v[76:79], v[72:75], v[88:103]
    ds_read_b128 v[72:75], v26 offset:160
    ds_read_b64 v[76:77], v27 offset:128
    ds_read_b64 v[78:79], v27 offset:136
    s_waitcnt lgkmcnt(9)
    v_mfma_f32_32x32x16_bf16 v[88:103], v[52:55], v[48:51], v[88:103]
    ds_read_b128 v[48:51], v26 offset:112
    ds_read_b64 v[52:53], v27 offset:96
    ds_read_b64 v[54:55], v27 offset:104
    s_waitcnt lgkmcnt(9)
    v_mfma_f32_32x32x16_bf16 v[88:103], v[60:63], v[56:59], v[88:103]
    ds_read_b128 v[56:59], v26 offset:80
    ds_read_b64 v[60:61], v27 offset:64
    ds_read_b64 v[62:63], v27 offset:72
    s_waitcnt lgkmcnt(9)
    v_mfma_f32_32x32x16_bf16 v[88:103], v[68:71], v[64:67], v[88:103]
    ds_read_b128 v[64:67], v26 offset:32
    ds_read_b64 v[68:69], v27 offset:32
    ds_read_b64 v[70:71], v27 offset:40
    s_waitcnt lgkmcnt(9)
    v_mfma_f32_32x32x16_bf16 v[88:103], v[76:79], v[72:75], v[88:103]
    ds_read_b128 v[72:75], v26 offset:0
    ds_read_b64 v[76:77], v27 offset:0
    ds_read_b64 v[78:79], v27 offset:8
    v_subrev_u32 v26, 320, v26
    v_subrev_u32 v27, 256, v27
    s_add_u32 s38, s38, 1
    s_cmp_lt_u32 s38, s36
    s_cbranch_scc1 cv_loop2
    s_waitcnt lgkmcnt(0)
    s_nop 11
    ds_write_b128 v31, v[88:91] offset:0
    ds_write_b128 v31, v[92:95] offset:1024
    ds_write_b128 v31, v[96:99] offset:2048
    ds_write_b128 v31, v[100:103] offset:3072
    s_waitcnt lgkmcnt(0)
    s_lshl_b32 s40, s29, 2
    v_add_u32 v30, s40, v112
    s_mov_b64 exec, 1
    ds_add_u32 v30, v113 offset:36
    s_mov_b64 exec, -1
    s_branch cv_join_60
cv_t1_59:
    s_lshl_b32 s40, s29, 2
    v_add_u32 v30, s40, v112
    s_mov_b32 s35, 0
spl_61:
    ds_read_b32 v8, v30 offset:36
    s_waitcnt lgkmcnt(0)
    v_readfirstlane_b32 s34, v8
    s_add_u32 s35, s35, 1
    s_nop 2
    s_cmp_ge_u32 s34, 1
    s_cbranch_scc1 spld_62
    s_cmp_ge_u32 s35, 0x400000
    s_cbranch_scc1 spld_62
    s_sleep 1
    s_branch spl_61
spld_62:
    ds_read_b128 v[88:91], v31 offset:0
    ds_read_b128 v[92:95], v31 offset:1024
    ds_read_b128 v[96:99], v31 offset:2048
    ds_read_b128 v[100:103], v31 offset:3072
    s_waitcnt lgkmcnt(0)
    v_add_f32 v32, v32, v88
    v_add_f32 v33, v33, v89
    v_add_f32 v34, v34, v90
    v_add_f32 v35, v35, v91
    v_add_f32 v36, v36, v92
    v_add_f32 v37, v37, v93
    v_add_f32 v38, v38, v94
    v_add_f32 v39, v39, v95
    v_add_f32 v40, v40, v96
    v_add_f32 v41, v41, v97
    v_add_f32 v42, v42, v98
    v_add_f32 v43, v43, v99
    v_add_f32 v44, v44, v100
    v_add_f32 v45, v45, v101
    v_add_f32 v46, v46, v102
    v_add_f32 v47, v47, v103
cv_join_60:
    s_nop 7
    v_cvt_pk_bf16_f32 v80, v32, v33
    v_cvt_pk_bf16_f32 v81, v34, v35
    v_cvt_pk_bf16_f32 v82, v36, v37
    v_cvt_pk_bf16_f32 v83, v38, v39
    v_cvt_pk_bf16_f32 v84, v40, v41
    v_cvt_pk_bf16_f32 v85, v42, v43
    v_cvt_pk_bf16_f32 v86, v44, v45
    v_cvt_pk_bf16_f32 v87, v46, v47
    v_lshlrev_b32 v24, 6, v24
    v_lshlrev_b32 v25, 5, v25
    v_add3_u32 v24, v24, v25, s31
    ds_write_b128 v24, v[80:83]
    ds_write_b128 v24, v[84:87] offset:16
    v_add_u32 v25, s31, v2
    s_waitcnt lgkmcnt(0)
    ds_read_b128 v[80:83], v25
    ds_read_b128 v[84:87], v25 offset:1024
    s_lshl_b32 s33, s27, 1
    s_add_u32 s33, s33, s29
    s_lshl_b32 s33, s33, 12
    s_lshl_b32 s34, s30, 11
    s_add_u32 s33, s33, s34
    s_add_u32 s33, s33, 14680064
    s_waitcnt lgkmcnt(0)
    s_mov_b64 exec, 1
    ds_add_u32 v112, v113 offset:16
    s_mov_b64 exec, -1
    buffer_store_dwordx4 v[80:83], v2, s[12:15], s33 offen sc1
    buffer_store_dwordx4 v[84:87], v2, s[12:15], s33 offen offset:1024 sc1
    s_mov_b32 s35, 0
spl_63:
    ds_read_b32 v8, v112 offset:0
    s_waitcnt lgkmcnt(0)
    v_readfirstlane_b32 s34, v8
    s_add_u32 s35, s35, 1
    s_nop 2
    s_cmp_ge_u32 s34, 1
    s_cbranch_scc1 spld_64
    s_cmp_ge_u32 s35, 0x400000
    s_cbranch_scc1 spld_64
    s_sleep 1
    s_branch spl_63
spld_64:
    s_lshl_b32 s36, s25, 16
    s_add_u32 s33, s28, 16
    s_lshl_b32 s35, s33, 10
    s_mul_i32 s39, s33, 1120
    s_add_u32 s36, s36, s35
    s_add_u32 s37, s36, 2097152
    s_add_u32 s34, s36, 4194304
    s_add_u32 s35, s35, 16384
    s_add_u32 s39, s39, 17920
    s_add_u32 s37, s37, 16384
    s_add_u32 s34, s34, 16384
    s_mov_b32 s41, 0
spl_65:
    ds_read_b32 v8, v112 offset:16
    s_waitcnt lgkmcnt(0)
    v_readfirstlane_b32 s40, v8
    s_add_u32 s41, s41, 1
    s_nop 2
    s_cmp_ge_u32 s40, 4
    s_cbranch_scc1 spld_66
    s_cmp_ge_u32 s41, 0x400000
    s_cbranch_scc1 spld_66
    s_sleep 1
    s_branch spl_65
spld_66:
    v_mul_u32_u24 v6, 1120, v1
    s_lshr_b32 s40, s28, 1
    s_lshl_b32 s40, s40, 6
    s_and_b32 s41, s28, 1
    s_lshl_b32 s42, s41, 4
    s_add_u32 s40, s40, s42
    s_add_u32 s40, s40, 102400
    v_add_u32 v6, s40, v6
    s_cmp_eq_u32 s41, 0
    s_cselect_b32 s40, 0x3f803f80, 0
    v_mov_b32 v8, s40
    v_mov_b32 v9, s40
    v_mov_b32 v10, s40
    v_mov_b32 v11, s40
    s_mov_b32 exec_hi, 0
    ds_write_b128 v6, v[8:11]
    s_mov_b64 exec, -1
    s_add_u32 m0, s35, 0
    s_nop 0
    buffer_load_dwordx4 v2, s[12:15], s37 offen sc1 lds
    s_add_u32 m0, s39, 65536
    s_add_u32 s37, s37, 4096
    buffer_load_dwordx4 v2, s[12:15], s34 offen sc1 lds
    s_add_u32 s34, s34, 4096
    s_add_u32 m0, s35, 4096
    s_nop 0
    buffer_load_dwordx4 v2, s[12:15], s37 offen sc1 lds
    s_add_u32 m0, s39, 70016
    s_add_u32 s37, s37, 4096
    buffer_load_dwordx4 v2, s[12:15], s34 offen sc1 lds
    s_add_u32 s34, s34, 4096
    s_add_u32 m0, s35, 8192
    s_nop 0
    buffer_load_dwordx4 v2, s[12:15], s37 offen sc1 lds
    s_add_u32 m0, s39, 74496
    s_add_u32 s37, s37, 4096
    buffer_load_dwordx4 v2, s[12:15], s34 offen sc1 lds
    s_add_u32 s34, s34, 4096
    s_add_u32 m0, s35, 12288
    s_nop 0
    buffer_load_dwordx4 v2, s[12:15], s37 offen sc1 lds
    s_add_u32 m0, s39, 78976
    s_add_u32 s37, s37, 4096
    buffer_load_dwordx4 v2, s[12:15], s34 offen sc1 lds
    s_add_u32 s34, s34, 4096
    s_add_u32 m0, s35, 16384
    s_nop 0
    buffer_load_dwordx4 v2, s[12:15], s37 offen sc1 lds
    s_add_u32 m0, s39, 83456
    s_add_u32 s37, s37, 4096
    buffer_load_dwordx4 v2, s[12:15], s34 offen sc1 lds
    s_add_u32 s34, s34, 4096
    s_add_u32 m0, s35, 20480
    s_nop 0
    buffer_load_dwordx4 v2, s[12:15], s37 offen sc1 lds
    s_add_u32 m0, s39, 87936
    s_add_u32 s37, s37, 4096
    buffer_load_dwordx4 v2, s[12:15], s34 offen sc1 lds
    s_add_u32 s34, s34, 4096
    s_add_u32 m0, s35, 24576
    s_nop 0
    buffer_load_dwordx4 v2, s[12:15], s37 offen sc1 lds
    s_add_u32 m0, s39, 92416
    s_add_u32 s37, s37, 4096
    buffer_load_dwordx4 v2, s[12:15], s34 offen sc1 lds
    s_add_u32 s34, s34, 4096
    s_add_u32 m0, s35, 28672
    s_nop 0
    buffer_load_dwordx4 v2, s[12:15], s37 offen sc1 lds
    s_add_u32 m0, s39, 96896
    s_add_u32 s37, s37, 4096
    buffer_load_dwordx4 v2, s[12:15], s34 offen sc1 lds
    s_add_u32 s34, s34, 4096
    s_waitcnt vmcnt(0) lgkmcnt(0)
    s_mov_b64 exec, 1
    ds_add_u32 v112, v113 offset:12
    s_mov_b64 exec, -1
    s_cmp_lg_u32 s28, 0
    s_cbranch_scc1 cv_nowt_67
    s_load_dwordx2 s[4:5], s[0:1], 16
    v_lshrrev_b32 v8, 3, v1
    v_lshlrev_b32 v8, 10, v8
    v_and_b32 v9, 7, v1
    v_lshlrev_b32 v9, 7, v9
    v_add_u32 v8, v8, v9
    s_lshr_b32 s40, s2, 3
    s_lshl_b32 s40, s40, 14
    s_add_u32 s41, s40, 8192
    s_waitcnt lgkmcnt(0)
    s_mov_b32 s16, s4
    s_and_b32 s17, s5, 0xffff
    s_mov_b32 s18, 0x80000
    s_mov_b32 s19, 0x20000
    buffer_load_dword v10, v8, s[16:19], s40 offen
    buffer_load_dword v10, v8, s[16:19], s41 offen
cv_nowt_67:
    s_lshr_b32 s40, s27, 2
    s_add_u32 s40, s40, 24
    s_lshl_b32 s40, s40, 12
    s_add_u32 s40, s40, 12582912
    v_mov_b32 v8, 0
    v_mov_b32 v9, 1
    s_mov_b64 exec, 1
    buffer_atomic_add v9, v8, s[12:15], s40 offen
    s_mov_b64 exec, -1
    v_mov_b32 v8, 0
    s_mov_b32 s42, 0
spg_68:
    buffer_load_dword v9, v8, s[12:15], s40 offen sc1
    s_waitcnt vmcnt(0)
    v_readfirstlane_b32 s41, v9
    s_add_u32 s42, s42, 1
    s_nop 2
    s_cmp_ge_u32 s41, 16
    s_cbranch_scc1 spgd_69
    s_cmp_ge_u32 s42, 0x80000
    s_cbranch_scc1 spgd_69
    s_sleep 1
    s_branch spg_68
spgd_69:
    s_lshr_b32 s41, s27, 2
    s_lshl_b32 s41, s41, 3
    s_and_b32 s42, s27, 3
    s_lshl_b32 s42, s42, 9
    s_lshl_b32 s43, s28, 7
    s_add_u32 s42, s42, s43
    v_lshrrev_b32 v2, 4, v1
    v_lshlrev_b32 v2, 12, v2
    v_and_b32 v3, 15, v1
    v_lshlrev_b32 v3, 4, v3
    v_add_u32 v2, v2, v3
    s_lshl_b32 s48, s41, 12
    s_lshl_b32 s49, s42, 1
    s_add_u32 s48, s48, s49
    s_add_u32 s48, s48, 14680064
    s_lshl_b32 s50, s28, 11
    s_add_u32 s50, s50, 153856
    s_mov_b32 m0, s50
    s_add_u32 s49, s48, 16384
    buffer_load_dwordx4 v2, s[12:15], s48 offen sc1 lds
    s_add_u32 m0, s50, 1024
    s_nop 0
    buffer_load_dwordx4 v2, s[12:15], s49 offen sc1 lds
    v_bfe_u32 v2, v1, 2, 2
    v_lshlrev_b32 v2, 8, v2
    v_lshrrev_b32 v3, 4, v1
    v_lshlrev_b32 v3, 5, v3
    v_and_b32 v4, 3, v1
    v_lshlrev_b32 v4, 3, v4
    v_add3_u32 v2, v2, v3, v4
    v_add_u32 v2, s50, v2
    v_lshlrev_b32 v3, 11, v1
    s_lshl_b32 s48, s42, 11
    s_lshl_b32 s49, s41, 1
    s_add_u32 s48, s48, s49
    s_add_u32 s48, s48, 1024
    s_add_u32 s49, s48, 131072
    s_waitcnt vmcnt(0)
    ds_read_b64_tr_b16 v[8:9], v2 offset:0
    ds_read_b64_tr_b16 v[10:11], v2 offset:1024
    ds_read_b64_tr_b16 v[12:13], v2 offset:128
    ds_read_b64_tr_b16 v[14:15], v2 offset:1152
    s_waitcnt lgkmcnt(0)
    buffer_store_dwordx4 v[8:11], v3, s[20:23], s48 offen
    buffer_store_dwordx4 v[12:15], v3, s[20:23], s49 offen
    s_waitcnt vmcnt(0)
    s_endpgm
mega_exit:
    s_endpgm
.section .rodata,"a"
.p2align 6
.amdhsa_kernel concat_heads__mha_block__ssm_conv_s4d__prompt_kernel
  .amdhsa_next_free_vgpr 160
  .amdhsa_next_free_sgpr 96
  .amdhsa_accum_offset 160
  .amdhsa_group_segment_fixed_size 0
  .amdhsa_kernarg_size 104
  .amdhsa_user_sgpr_count 2
  .amdhsa_user_sgpr_kernarg_segment_ptr 1
  .amdhsa_system_sgpr_workgroup_id_x 1
  .amdhsa_ieee_mode 0
.end_amdhsa_kernel
```
